```python
import torch

def _softmax(x, axis=-1):
    return torch.softmax(x, dim=axis)
def _gelu(x):
    return torch.nn.functional.gelu(x, approximate="tanh")
def _silu(x):
    return torch.nn.functional.silu(x)
def _sigmoid(x):
    return torch.sigmoid(x)
def _layernorm(x, axis=-1, eps=1e-5):
    m = x.mean(dim=axis, keepdim=True)
    v = x.var(dim=axis, keepdim=True, unbiased=False)
    return (x - m) / torch.sqrt(v + eps)
def _scatter_add(tgt, idx, src, axis=0):
    return tgt.clone().index_add_(axis, idx, src)
def _segment_sum(src, seg, n):
    out = torch.zeros((n,) + src.shape[1:], dtype=src.dtype)
    return out.index_add_(0, seg, src)
def _pad(x, pw):
    flat = tuple(v for pair in reversed(pw) for v in pair)
    return torch.nn.functional.pad(x, flat)

kernel_name = 'parallel_sum__ssm_conv_h3__dense_activation_squared_relu__prompt'

def setup_inputs():

    _w = (lambda a: (lambda t: t.to(torch.bfloat16) if t.is_floating_point() else t)(torch.as_tensor(a)))
    def _A_setup():
        B, S, D = 1, 2048, 512
        ks = 4
        return {
            "q": _w((lambda *s: torch.randn(*s, dtype=torch.bfloat16) * 0.05)(B, S, D)),
            "k": _w((lambda *s: torch.randn(*s, dtype=torch.bfloat16) * 0.8)(B, S, D)),
            "v": _w((lambda *s: torch.randn(*s, dtype=torch.bfloat16) * 0.8)(B, S, D)),
            "shift_k": _w((lambda *s: torch.randn(*s, dtype=torch.bfloat16) * 0.8)(D, ks) * 0.5),
            "ssm_k": _w((lambda *s: torch.randn(*s, dtype=torch.bfloat16) * 0.8)(D, S) * (1.0 / S ** 0.5)),
            "ssm_D": _w((lambda *s: torch.randn(*s, dtype=torch.bfloat16) * 0.8)(D)),
        }
    _A_in = _A_setup()

    def _B_setup():
        B, S, D, F = 1, 2048, 512, 1792
        return {
            "x": _w((lambda *s: torch.randn(*s, dtype=torch.bfloat16) * 0.05)(B, S, D)),
            "w1": _w((lambda *s: torch.randn(*s, dtype=torch.bfloat16) * 0.05)(D, F)),
            "b1": _w((lambda *s: torch.randn(*s, dtype=torch.bfloat16) * 0.2)(F)),
            "w2": _w((lambda *s: torch.randn(*s, dtype=torch.bfloat16) * 0.05)(F, D)),
            "b2": _w((lambda *s: torch.randn(*s, dtype=torch.bfloat16) * 1.6)(D)),
        }
    _B_in = _B_setup()

    return {
        "A_q": _A_in["q"],
        "A_k": _A_in["k"],
        "A_v": _A_in["v"],
        "A_shift_k": _A_in["shift_k"],
        "A_ssm_k": _A_in["ssm_k"],
        "A_ssm_D": _A_in["ssm_D"],
        "B_x": _B_in["x"],
        "B_w1": _B_in["w1"],
        "B_b1": _B_in["b1"],
        "B_w2": _B_in["w2"],
        "B_b2": _B_in["b2"],
    }

def reference(A_q, A_k, A_v, A_shift_k, A_ssm_k, A_ssm_D, B_x, B_w1, B_b1, B_w2, B_b2):
    def _A_ref(q, k, v, shift_k, ssm_k, ssm_D):
        B, S, D = q.shape
        ks = shift_k.shape[-1]
        k_pad = _pad(k, ((0, 0), (ks - 1, 0), (0, 0)))
        k_shift = torch.zeros_like(k)
        for t in range(ks):
            k_shift = k_shift + k_pad[:, t:t + S, :] * shift_k[:, ks - 1 - t][None, None, :]
        kv = k_shift * v
        L = 2 * S
        kv_pad = _pad(kv, ((0, 0), (0, S), (0, 0)))
        kf_pad = _pad(ssm_k, ((0, 0), (0, S)))
        kv_f = (lambda x, axes=(-2,-1): torch.fft.rfft2(x.float(), dim=axes))(kv_pad[:, None, :, :], axes=(1, 2))
        kf_f = (lambda x, axes=(-2,-1): torch.fft.rfft2(x.float(), dim=axes))(kf_pad[:, None, :], axes=(1, 2))
        kf_f = (lambda x, *d: x.permute(*d))(kf_f, 1, 2, 0)
        y_f = kv_f * kf_f[None, :, :, :]
        y = (lambda x, s, axes=(-2,-1): torch.fft.irfft2(x, s=s, dim=axes).to(torch.bfloat16))(y_f, (1, L), axes=(1, 2))[:, 0, :S, :]
        y = y + kv * ssm_D[None, None, :]
        return q * y

    def _B_ref(x, w1, b1, w2, b2):
        h = torch.einsum("bsd,df->bsf", x, w1) + b1
        zero = torch.zeros_like(h)
        r = torch.where(h > zero, h, zero)
        h = r * r
        out = torch.einsum("bsf,fd->bsd", h, w2) + b2
        return out

    x = A_q
    xn = _layernorm(x, axis=-1)
    return x + _A_ref(xn, A_k, A_v, A_shift_k, A_ssm_k, A_ssm_D) + _B_ref(xn, B_w1, B_b1, B_w2, B_b2)
```

```asm
; @launch grid=(256,1,1) block=(256,1,1) lds=157184
.amdgcn_target "amdgcn-amd-amdhsa--gfx950"
.text
.globl parallel_sum__ssm_conv_h3__dense_activation_squared_relu__prompt_kernel
.p2align 8
.type parallel_sum__ssm_conv_h3__dense_activation_squared_relu__prompt_kernel,@function
parallel_sum__ssm_conv_h3__dense_activation_squared_relu__prompt_kernel:
    s_cmp_ge_u32 s2, 256
    s_cbranch_scc1 L_end
    s_load_dwordx16 s[4:19], s[0:1], 0
    s_load_dwordx8 s[20:27], s[0:1], 64
    s_load_dwordx4 s[28:31], s[0:1], 96
    s_memrealtime s[34:35]
    v_and_b32 v1, 63, v0
    v_lshrrev_b32 v2, 6, v0
    s_nop 0
    v_readfirstlane_b32 s32, v2
    s_lshr_b32 s60, s2, 3
    s_and_b32 s61, s2, 7
    v_lshrrev_b32 v8, 3, v1
    v_and_b32 v10, 7, v1
    v_lshlrev_b32 v12, 10, v8
    v_lshl_add_u32 v12, v10, 4, v12
    s_lshl_b32 s64, s60, 16
    s_lshl_b32 s65, s61, 7
    s_add_u32 s64, s64, s65
    s_lshl_b32 s65, s32, 13
    s_add_u32 s65, s65, s64
    v_add_u32 v13, s65, v12
    v_add_u32 v14, 32768, v13
    s_sub_u32 s65, s64, 8192
    s_cmp_eq_u32 s60, 0
    s_cselect_b32 s65, 2146435072, s65
    v_add_u32 v15, s65, v12
    s_waitcnt lgkmcnt(0)
    s_mov_b32 s36, s6
    s_mov_b32 s37, s7
    s_mov_b32 s38, 2097152
    s_mov_b32 s39, 0x00020000
    s_mov_b32 s40, s8
    s_mov_b32 s41, s9
    s_mov_b32 s42, 2097152
    s_mov_b32 s43, 0x00020000
    s_mul_i32 s66, s32, 1040
    s_add_u32 s66, s66, 131072
    s_mov_b32 m0, 131072
    s_nop 0
    buffer_load_dwordx4 v15, s[36:39], 0 offen lds
    s_add_u32 m0, s66, 1040
    s_nop 0
    buffer_load_dwordx4 v13, s[36:39], 0 offen lds
    s_add_u32 m0, s66, 5200
    s_nop 0
    buffer_load_dwordx4 v14, s[36:39], 0 offen lds
    s_add_u32 m0, s66, 9360
    s_nop 0
    buffer_load_dwordx4 v13, s[40:43], 0 offen lds
    s_add_u32 m0, s66, 13520
    s_nop 0
    buffer_load_dwordx4 v14, s[40:43], 0 offen lds
    s_mov_b32 s44, s10
    s_mov_b32 s45, s11
    s_mov_b32 s46, 4096
    s_mov_b32 s47, 0x00020000
    v_lshl_add_u32 v13, v2, 3, v8
    s_lshl_b32 s65, s61, 9
    v_lshlrev_b32 v14, 4, v13
    v_add_u32 v14, s65, v14
    buffer_load_dwordx4 v[40:43], v14, s[44:47], 0 offen
    s_mov_b32 s44, s4
    s_mov_b32 s45, s5
    s_mov_b32 s46, 2097152
    s_mov_b32 s47, 0x00020000
    s_and_b32 s65, s2, 7
    s_lshl_b32 s65, s65, 18
    s_lshr_b32 s66, s2, 3
    s_lshl_b32 s66, s66, 13
    s_add_u32 s65, s65, s66
    s_lshl_b32 s66, s32, 11
    s_add_u32 s65, s65, s66
    v_lshrrev_b32 v14, 5, v1
    v_lshlrev_b32 v14, 10, v14
    v_and_b32 v15, 31, v1
    v_lshl_add_u32 v14, v15, 4, v14
    v_add_u32 v14, s65, v14
    buffer_load_dwordx4 v[100:103], v14, s[44:47], 0 offen
    buffer_load_dwordx4 v[104:107], v14, s[44:47], 0 offen offset:512
    s_cmp_lg_u32 s32, 0
    s_cbranch_scc1 L_now0
    s_cmp_lg_u32 s2, 0
    s_cbranch_scc1 L_now0
    s_or_b32 s34, s34, 1
    v_mov_b32 v3, 0
    v_mov_b32 v4, s34
    s_mov_b64 exec, 1
    global_store_dword v3, v4, s[28:29] sc1
    s_mov_b64 exec, -1
L_now0:
    s_add_u32 s76, s30, 13631488
    s_addc_u32 s77, s31, 0
    s_mov_b32 s78, 131072
    s_mov_b32 s79, 0x00020000
    s_cmp_ge_u32 s2, 224
    s_cbranch_scc1 L_stats
    s_and_b32 s60, s2, 7
    s_lshr_b32 s61, s2, 3
    s_lshr_b32 s64, s60, 1
    s_lshl_b32 s64, s64, 2
    s_and_b32 s62, s61, 3
    s_add_u32 s64, s64, s62
    s_and_b32 s65, s60, 1
    s_mul_i32 s65, s65, 7
    s_lshr_b32 s62, s61, 2
    s_add_u32 s65, s65, s62
    s_lshr_b32 s66, s32, 1
    s_and_b32 s67, s32, 1
    s_mov_b32 s48, s4
    s_mov_b32 s49, s5
    s_mov_b32 s50, 2097152
    s_mov_b32 s51, 0x00020000
    s_mov_b32 s52, s18
    s_mov_b32 s53, s19
    s_mov_b32 s54, 1835008
    s_mov_b32 s55, 0x00020000
    v_lshrrev_b32 v9, 4, v1
    v_xor_b32 v11, v10, v9
    v_lshlrev_b32 v11, 4, v11
    v_lshl_add_u32 v11, v8, 10, v11
    s_lshl_b32 s62, s64, 17
    s_lshl_b32 s63, s32, 15
    s_add_u32 s62, s62, s63
    v_add_u32 v44, s62, v11
    v_xor_b32 v45, 64, v44
    v_add_u32 v45, 8192, v45
    v_add_u32 v46, 16384, v44
    v_add_u32 v47, 16384, v45
    v_and_b32 v11, 15, v1
    v_lshlrev_b32 v16, 2, v9
    v_xor_b32 v11, v11, v16
    v_lshlrev_b32 v11, 4, v11
    v_mul_u32_u24 v16, 3584, v9
    v_add_u32 v11, v11, v16
    s_mul_i32 s62, s32, 57344
    s_lshl_b32 s63, s65, 8
    s_add_u32 s62, s62, s63
    v_add_u32 v48, s62, v11
    v_add_u32 v49, 14336, v48
    v_add_u32 v50, 28672, v48
    v_add_u32 v51, 43008, v48
    s_lshl_b32 s68, s32, 12
    s_and_b32 s62, s61, 3
    s_lshl_b32 s62, s62, 1
    s_lshr_b32 s63, s61, 2
    s_add_u32 s34, s62, s63
    s_and_b32 s34, s34, 7
    s_mov_b32 s34, 0
    s_lshl_b32 s69, s34, 7
    s_mul_i32 s70, s34, 229376
    s_add_u32 m0, s68, 0
    s_nop 0
    buffer_load_dwordx4 v44, s[48:51], s69 offen lds
    s_add_u32 m0, s68, 1024
    s_nop 0
    buffer_load_dwordx4 v45, s[48:51], s69 offen lds
    s_add_u32 m0, s68, 2048
    s_nop 0
    buffer_load_dwordx4 v46, s[48:51], s69 offen lds
    s_add_u32 m0, s68, 3072
    s_nop 0
    buffer_load_dwordx4 v47, s[48:51], s69 offen lds
    s_add_u32 m0, s68, 16384
    s_nop 0
    buffer_load_dwordx4 v48, s[52:55], s70 offen lds
    s_add_u32 m0, s68, 17408
    s_nop 0
    buffer_load_dwordx4 v49, s[52:55], s70 offen lds
    s_add_u32 m0, s68, 18432
    s_nop 0
    buffer_load_dwordx4 v50, s[52:55], s70 offen lds
    s_add_u32 m0, s68, 19456
    s_nop 0
    buffer_load_dwordx4 v51, s[52:55], s70 offen lds
    s_add_u32 s69, s69, 128
    s_add_u32 s70, s70, 229376
    s_lshl_b32 s62, s2, 6
    s_and_b32 s63, s2, 7
    s_lshl_b32 s63, s63, 6
    s_lshr_b32 s44, s2, 3
    s_lshl_b32 s44, s44, 1
    s_add_u32 s63, s63, s44
    s_lshl_b32 s63, s63, 5
    s_cmp_lt_u32 s32, 2
    s_cselect_b32 s62, s62, s63
    s_and_b32 s63, s32, 1
    s_lshl_b32 s63, s63, 5
    s_add_u32 s62, s62, s63
    v_and_b32 v18, 31, v1
    v_add_u32 v18, s62, v18
    s_cmp_lt_u32 s32, 2
    s_cselect_b32 s44, s22, s12
    s_cselect_b32 s45, s23, s13
    s_mov_b32 s46, 2097152
    s_cselect_b32 s46, 1835008, s46
    s_mov_b32 s47, 0x00020000
    s_lshr_b32 s63, s46, 7
    s_sub_u32 s63, s63, 1
    v_min_u32 v18, s63, v18
    v_lshlrev_b32 v18, 7, v18
    buffer_load_dword v19, v18, s[44:47], 0 offen
    v_lshrrev_b32 v8, 5, v1
    v_and_b32 v10, 31, v1
    v_bfe_u32 v11, v1, 1, 3
    s_lshl_b32 s62, s67, 13
    v_lshlrev_b32 v16, 7, v10
    v_add_u32 v16, s62, v16
    v_add_u32 v17, 0, v8
    v_xor_b32 v17, v17, v11
    v_lshl_add_u32 v112, v17, 4, v16
    v_add_u32 v116, 0x10000, v112
    v_add_u32 v17, 2, v8
    v_xor_b32 v17, v17, v11
    v_lshl_add_u32 v113, v17, 4, v16
    v_add_u32 v117, 0x10000, v113
    v_add_u32 v17, 4, v8
    v_xor_b32 v17, v17, v11
    v_lshl_add_u32 v114, v17, 4, v16
    v_add_u32 v118, 0x10000, v114
    v_add_u32 v17, 6, v8
    v_xor_b32 v17, v17, v11
    v_lshl_add_u32 v115, v17, 4, v16
    v_add_u32 v119, 0x10000, v115
    v_and_b32 v10, 15, v1
    v_lshrrev_b32 v11, 2, v10
    v_bfe_u32 v16, v1, 4, 1
    v_lshl_add_u32 v17, v8, 3, v11
    v_lshlrev_b32 v17, 8, v17
    v_bfe_u32 v18, v1, 1, 1
    v_lshl_add_u32 v18, v16, 1, v18
    v_lshl_add_u32 v17, v18, 4, v17
    v_and_b32 v18, 1, v1
    v_lshl_add_u32 v17, v18, 3, v17
    v_add_u32 v17, 16384, v17
    s_lshl_b32 s62, s66, 1
    s_add_u32 s62, s62, 0
    v_xor_b32 v18, s62, v11
    v_lshl_add_u32 v120, v18, 6, v17
    v_add_u32 v122, 0x10000, v120
    s_lshl_b32 s62, s66, 1
    s_add_u32 s62, s62, 1
    v_xor_b32 v18, s62, v11
    v_lshl_add_u32 v121, v18, 6, v17
    v_add_u32 v123, 0x10000, v121
    v_mov_b32 v128, 0
    v_mov_b32 v129, 0
    v_mov_b32 v130, 0
    v_mov_b32 v131, 0
    v_mov_b32 v132, 0
    v_mov_b32 v133, 0
    v_mov_b32 v134, 0
    v_mov_b32 v135, 0
    v_mov_b32 v136, 0
    v_mov_b32 v137, 0
    v_mov_b32 v138, 0
    v_mov_b32 v139, 0
    v_mov_b32 v140, 0
    v_mov_b32 v141, 0
    v_mov_b32 v142, 0
    v_mov_b32 v143, 0
    v_mov_b32 v144, 0
    v_mov_b32 v145, 0
    v_mov_b32 v146, 0
    v_mov_b32 v147, 0
    v_mov_b32 v148, 0
    v_mov_b32 v149, 0
    v_mov_b32 v150, 0
    v_mov_b32 v151, 0
    v_mov_b32 v152, 0
    v_mov_b32 v153, 0
    v_mov_b32 v154, 0
    v_mov_b32 v155, 0
    v_mov_b32 v156, 0
    v_mov_b32 v157, 0
    v_mov_b32 v158, 0
    v_mov_b32 v159, 0
    v_mov_b32 v160, 0
    v_mov_b32 v161, 0
    v_mov_b32 v162, 0
    v_mov_b32 v163, 0
    v_mov_b32 v164, 0
    v_mov_b32 v165, 0
    v_mov_b32 v166, 0
    v_mov_b32 v167, 0
    v_mov_b32 v168, 0
    v_mov_b32 v169, 0
    v_mov_b32 v170, 0
    v_mov_b32 v171, 0
    v_mov_b32 v172, 0
    v_mov_b32 v173, 0
    v_mov_b32 v174, 0
    v_mov_b32 v175, 0
    v_mov_b32 v176, 0
    v_mov_b32 v177, 0
    v_mov_b32 v178, 0
    v_mov_b32 v179, 0
    v_mov_b32 v180, 0
    v_mov_b32 v181, 0
    v_mov_b32 v182, 0
    v_mov_b32 v183, 0
    v_mov_b32 v184, 0
    v_mov_b32 v185, 0
    v_mov_b32 v186, 0
    v_mov_b32 v187, 0
    v_mov_b32 v188, 0
    v_mov_b32 v189, 0
    v_mov_b32 v190, 0
    v_mov_b32 v191, 0
    s_add_u32 s40, s30, 12582912
    s_addc_u32 s41, s31, 0
    s_mov_b32 s42, 79872
    s_mov_b32 s43, 0x00020000
    s_mov_b32 s56, s20
    s_mov_b32 s57, s21
    s_mov_b32 s58, 3584
    s_mov_b32 s59, 0x00020000
    v_and_b32 v96, 31, v1
    s_lshl_b32 s62, s64, 7
    s_lshl_b32 s63, s67, 6
    s_add_u32 s62, s62, s63
    v_add_u32 v97, s62, v96
    v_lshlrev_b32 v97, 3, v97
    s_lshl_b32 s62, s65, 7
    s_lshl_b32 s63, s66, 6
    s_add_u32 s62, s62, s63
    v_add_u32 v98, s62, v96
    v_lshlrev_b32 v99, 3, v98
    v_add_u32 v99, 65536, v99
    v_lshlrev_b32 v98, 1, v98
    s_lshr_b32 s71, s32, 1
    s_and_b32 s72, s32, 1
    s_and_b32 s60, s2, 7
    s_lshl_b32 s73, s60, 6
    s_lshr_b32 s60, s2, 3
    s_lshl_b32 s60, s60, 1
    s_add_u32 s73, s73, s60
    s_add_u32 s73, s73, s71
    s_lshl_b32 s74, s73, 12
    s_mul_i32 s62, s71, 4608
    s_add_u32 s62, s62, 33792
    s_mul_i32 s63, s71, 16640
    s_sub_u32 s60, s62, 512
    v_and_b32 v4, 31, v1
    v_lshlrev_b32 v4, 4, v4
    v_add_u32 v4, s60, v4
    v_accvgpr_write_b32 a112, v4
    s_lshl_b32 s60, s72, 11
    s_add_u32 s60, s60, s62
    v_lshlrev_b32 v4, 4, v1
    v_add_u32 v4, s60, v4
    v_accvgpr_write_b32 a113, v4
    v_and_b32 v4, 15, v1
    v_add_u32 v4, 1, v4
    v_lshrrev_b32 v5, 4, v1
    v_and_b32 v6, 3, v4
    v_mul_u32_u24 v6, 4160, v6
    v_and_b32 v7, 0x1c, v4
    v_lshl_add_u32 v7, v5, 3, v7
    v_lshl_add_u32 v6, v7, 1, v6
    s_lshl_b32 s60, s72, 8
    s_add_u32 s60, s60, s63
    v_add_u32 v6, s60, v6
    v_accvgpr_write_b32 a114, v6
    v_and_b32 v4, 15, v1
    v_lshlrev_b32 v4, 5, v4
    v_lshlrev_b32 v5, 4, v5
    v_sub_u32 v4, v4, v5
    s_lshl_b32 s60, s72, 8
    s_sub_u32 s60, s62, s60
    s_add_u32 s60, s60, 16
    s_sub_u32 s60, s60, 256
    v_add_u32 v4, s60, v4
    v_accvgpr_write_b32 a115, v4
    v_lshrrev_b32 v5, 5, v1
    v_and_b32 v6, 15, v1
    v_lshrrev_b32 v7, 2, v6
    v_lshl_add_u32 v8, v5, 2, v7
    v_lshlrev_b32 v8, 7, v8
    v_bfe_u32 v9, v1, 4, 1
    v_bfe_u32 v10, v1, 1, 1
    v_lshl_add_u32 v9, v9, 1, v10
    v_lshl_add_u32 v8, v9, 4, v8
    v_and_b32 v9, 1, v1
    v_lshl_add_u32 v8, v9, 3, v8
    s_lshl_b32 s60, s32, 11
    s_add_u32 s60, s60, 42496
    v_bfe_u32 v9, v1, 3, 1
    v_add_u32 v8, s60, v8
    v_xor_b32 v10, 0, v9
    v_lshl_add_u32 v10, v10, 6, v8
    v_accvgpr_write_b32 a116, v10
    v_xor_b32 v10, 1, v9
    v_lshl_add_u32 v10, v10, 6, v8
    v_accvgpr_write_b32 a117, v10
    s_and_b32 s60, s2, 7
    s_lshl_b32 s62, s60, 2
    s_lshr_b32 s61, s2, 3
    s_and_b32 s60, s61, 3
    s_add_u32 s62, s62, s60
    s_lshr_b32 s63, s61, 2
    v_lshrrev_b32 v8, 2, v1
    v_and_b32 v9, 3, v1
    v_bfe_u32 v10, v1, 4, 2
    v_xor_b32 v9, v9, v10
    v_lshlrev_b32 v9, 4, v9
    v_lshl_add_u32 v9, v8, 10, v9
    s_lshl_b32 s60, s62, 16
    s_and_b32 s61, s32, 1
    s_lshl_b32 s61, s61, 15
    s_add_u32 s60, s60, s61
    s_lshl_b32 s61, s63, 7
    s_add_u32 s60, s60, s61
    s_lshr_b32 s61, s32, 1
    s_lshl_b32 s61, s61, 6
    s_add_u32 s60, s60, s61
    v_add_u32 v9, s60, v9
    v_accvgpr_write_b32 a118, v9
    s_lshr_b32 s60, s62, 1
    s_lshl_b32 s60, s60, 4
    s_add_u32 s60, s60, 512
    s_lshl_b32 s60, s60, 7
    v_cmp_gt_u32 vcc, 14, v1
    s_nop 1
    v_cndmask_b32 v9, 0, v1, vcc
    v_lshlrev_b32 v9, 7, v9
    v_add_u32 v9, s60, v9
    v_accvgpr_write_b32 a119, v9
    s_lshl_b32 s60, s62, 1
    s_mul_i32 s60, s60, 112
    s_mul_i32 s61, s32, 28
    s_add_u32 s60, s60, s61
    s_lshl_b32 s60, s60, 10
    v_lshlrev_b32 v9, 4, v1
    v_add_u32 v9, s60, v9
    v_accvgpr_write_b32 a120, v9
    s_lshl_b32 s60, s62, 6
    s_and_b32 s61, s32, 1
    s_lshl_b32 s61, s61, 5
    s_add_u32 s60, s60, s61
    v_and_b32 v9, 31, v1
    v_add_u32 v9, s60, v9
    v_lshlrev_b32 v9, 3, v9
    v_accvgpr_write_b32 a121, v9
    v_and_b32 v8, 31, v1
    v_bfe_u32 v9, v1, 2, 2
    s_lshl_b32 s60, s32, 11
    s_add_u32 s60, s60, 24576
    v_lshlrev_b32 v8, 6, v8
    v_lshl_add_u32 v8, v5, 3, v8
    v_add_u32 v8, s60, v8
    v_xor_b32 v10, 0, v9
    v_lshl_add_u32 v10, v10, 4, v8
    v_accvgpr_write_b32 a122, v10
    v_xor_b32 v10, 1, v9
    v_lshl_add_u32 v10, v10, 4, v8
    v_accvgpr_write_b32 a123, v10
    v_xor_b32 v10, 2, v9
    v_lshl_add_u32 v10, v10, 4, v8
    v_accvgpr_write_b32 a124, v10
    v_xor_b32 v10, 3, v9
    v_lshl_add_u32 v10, v10, 4, v8
    v_accvgpr_write_b32 a125, v10
    s_waitcnt vmcnt(9)
    s_barrier
    v_mov_b32 v54, 0
    global_load_dword v55, v54, s[28:29] sc1
    v_and_b32 v12, 7, v1
    v_mul_u32_u24 v14, 1040, v12
    v_lshl_add_u32 v14, v13, 2, v14
    v_add_u32 v14, 131072, v14
    ds_read_b32 v20, v14 offset:640
    ds_read_b32 v21, v14 offset:768
    ds_read_b32 v22, v14 offset:896
    ds_read_b32 v23, v14 offset:1040
    ds_read_b32 v24, v14 offset:1168
    ds_read_b32 v25, v14 offset:1296
    ds_read_b32 v26, v14 offset:1424
    ds_read_b32 v27, v14 offset:1552
    ds_read_b32 v28, v14 offset:1680
    ds_read_b32 v29, v14 offset:1808
    ds_read_b32 v30, v14 offset:1936
    ds_read_b32 v32, v14 offset:9360
    ds_read_b32 v33, v14 offset:9488
    ds_read_b32 v34, v14 offset:9616
    ds_read_b32 v35, v14 offset:9744
    ds_read_b32 v36, v14 offset:9872
    ds_read_b32 v37, v14 offset:10000
    ds_read_b32 v38, v14 offset:10128
    ds_read_b32 v39, v14 offset:10256
    v_lshlrev_b32 v56, 16, v40
    v_and_b32 v57, 0xffff0000, v40
    v_lshlrev_b32 v58, 16, v41
    v_and_b32 v59, 0xffff0000, v41
    v_lshlrev_b32 v60, 16, v42
    v_and_b32 v61, 0xffff0000, v42
    v_lshlrev_b32 v62, 16, v43
    v_and_b32 v63, 0xffff0000, v43
    s_waitcnt lgkmcnt(8)
    v_lshlrev_b32 v196, 16, v20
    v_and_b32 v207, 0xffff0000, v20
    v_lshlrev_b32 v197, 16, v21
    v_and_b32 v208, 0xffff0000, v21
    v_lshlrev_b32 v198, 16, v22
    v_and_b32 v209, 0xffff0000, v22
    s_add_u32 m0, s68, 32768
    s_nop 0
    buffer_load_dwordx4 v44, s[48:51], s69 offen lds
    v_lshlrev_b32 v199, 16, v23
    v_and_b32 v210, 0xffff0000, v23
    v_lshlrev_b32 v200, 16, v24
    v_and_b32 v211, 0xffff0000, v24
    v_lshlrev_b32 v201, 16, v25
    v_and_b32 v212, 0xffff0000, v25
    v_lshlrev_b32 v202, 16, v26
    v_and_b32 v213, 0xffff0000, v26
    v_lshlrev_b32 v203, 16, v27
    v_and_b32 v214, 0xffff0000, v27
    v_lshlrev_b32 v204, 16, v28
    v_and_b32 v215, 0xffff0000, v28
    v_lshlrev_b32 v205, 16, v29
    v_and_b32 v216, 0xffff0000, v29
    v_lshlrev_b32 v206, 16, v30
    s_add_u32 m0, s68, 33792
    s_nop 0
    buffer_load_dwordx4 v45, s[48:51], s69 offen lds
    v_and_b32 v217, 0xffff0000, v30
    v_mul_f32 v220, v199, v56
    v_fmac_f32 v220, v198, v57
    v_fmac_f32 v220, v197, v58
    v_fmac_f32 v220, v196, v59
    v_mul_f32 v221, v200, v56
    v_fmac_f32 v221, v199, v57
    v_fmac_f32 v221, v198, v58
    v_fmac_f32 v221, v197, v59
    v_mul_f32 v222, v201, v56
    v_fmac_f32 v222, v200, v57
    v_fmac_f32 v222, v199, v58
    v_fmac_f32 v222, v198, v59
    v_mul_f32 v223, v202, v56
    v_fmac_f32 v223, v201, v57
    s_add_u32 m0, s68, 34816
    s_nop 0
    buffer_load_dwordx4 v46, s[48:51], s69 offen lds
    v_fmac_f32 v223, v200, v58
    v_fmac_f32 v223, v199, v59
    v_mul_f32 v224, v203, v56
    v_fmac_f32 v224, v202, v57
    v_fmac_f32 v224, v201, v58
    v_fmac_f32 v224, v200, v59
    v_mul_f32 v225, v204, v56
    v_fmac_f32 v225, v203, v57
    v_fmac_f32 v225, v202, v58
    v_fmac_f32 v225, v201, v59
    v_mul_f32 v226, v205, v56
    v_fmac_f32 v226, v204, v57
    v_fmac_f32 v226, v203, v58
    v_fmac_f32 v226, v202, v59
    v_mul_f32 v227, v206, v56
    s_add_u32 m0, s68, 35840
    s_nop 0
    buffer_load_dwordx4 v47, s[48:51], s69 offen lds
    v_fmac_f32 v227, v205, v57
    v_fmac_f32 v227, v204, v58
    v_fmac_f32 v227, v203, v59
    v_mul_f32 v228, v210, v60
    v_fmac_f32 v228, v209, v61
    v_fmac_f32 v228, v208, v62
    v_fmac_f32 v228, v207, v63
    v_mul_f32 v229, v211, v60
    v_fmac_f32 v229, v210, v61
    v_fmac_f32 v229, v209, v62
    v_fmac_f32 v229, v208, v63
    v_mul_f32 v230, v212, v60
    v_fmac_f32 v230, v211, v61
    v_fmac_f32 v230, v210, v62
    v_fmac_f32 v230, v209, v63
    s_add_u32 m0, s68, 49152
    s_nop 0
    buffer_load_dwordx4 v48, s[52:55], s70 offen lds
    v_mul_f32 v231, v213, v60
    v_fmac_f32 v231, v212, v61
    v_fmac_f32 v231, v211, v62
    v_fmac_f32 v231, v210, v63
    v_mul_f32 v232, v214, v60
    v_fmac_f32 v232, v213, v61
    v_fmac_f32 v232, v212, v62
    v_fmac_f32 v232, v211, v63
    v_mul_f32 v233, v215, v60
    v_fmac_f32 v233, v214, v61
    v_fmac_f32 v233, v213, v62
    v_fmac_f32 v233, v212, v63
    v_mul_f32 v234, v216, v60
    v_fmac_f32 v234, v215, v61
    v_fmac_f32 v234, v214, v62
    s_add_u32 m0, s68, 50176
    s_nop 0
    buffer_load_dwordx4 v49, s[52:55], s70 offen lds
    v_fmac_f32 v234, v213, v63
    v_mul_f32 v235, v217, v60
    v_fmac_f32 v235, v216, v61
    v_fmac_f32 v235, v215, v62
    v_fmac_f32 v235, v214, v63
    s_waitcnt lgkmcnt(0)
    v_lshlrev_b32 v5, 16, v32
    v_and_b32 v6, 0xffff0000, v32
    v_mul_f32 v220, v220, v5
    v_mul_f32 v228, v228, v6
    v_lshlrev_b32 v5, 16, v33
    v_and_b32 v6, 0xffff0000, v33
    v_mul_f32 v221, v221, v5
    v_mul_f32 v229, v229, v6
    v_lshlrev_b32 v5, 16, v34
    s_add_u32 m0, s68, 51200
    s_nop 0
    buffer_load_dwordx4 v50, s[52:55], s70 offen lds
    v_and_b32 v6, 0xffff0000, v34
    v_mul_f32 v222, v222, v5
    v_mul_f32 v230, v230, v6
    v_lshlrev_b32 v5, 16, v35
    v_and_b32 v6, 0xffff0000, v35
    v_mul_f32 v223, v223, v5
    v_mul_f32 v231, v231, v6
    v_lshlrev_b32 v5, 16, v36
    v_and_b32 v6, 0xffff0000, v36
    v_mul_f32 v224, v224, v5
    v_mul_f32 v232, v232, v6
    v_lshlrev_b32 v5, 16, v37
    v_and_b32 v6, 0xffff0000, v37
    v_mul_f32 v225, v225, v5
    v_mul_f32 v233, v233, v6
    s_add_u32 m0, s68, 52224
    s_nop 0
    buffer_load_dwordx4 v51, s[52:55], s70 offen lds
    s_add_u32 s69, s69, 128
    s_add_u32 s70, s70, 229376
    v_lshlrev_b32 v5, 16, v38
    v_and_b32 v6, 0xffff0000, v38
    v_mul_f32 v226, v226, v5
    v_mul_f32 v234, v234, v6
    v_lshlrev_b32 v5, 16, v39
    v_and_b32 v6, 0xffff0000, v39
    v_mul_f32 v227, v227, v5
    v_mul_f32 v235, v235, v6
    v_cvt_pk_bf16_f32 v236, v227, v226
    v_cvt_pk_bf16_f32 v237, v225, v224
    v_cvt_pk_bf16_f32 v238, v223, v222
    v_cvt_pk_bf16_f32 v239, v221, v220
    v_cvt_pk_bf16_f32 v240, v235, v234
    v_cvt_pk_bf16_f32 v241, v233, v232
    v_cvt_pk_bf16_f32 v242, v231, v230
    v_cvt_pk_bf16_f32 v243, v229, v228
    s_mov_b32 s36, s30
    s_mov_b32 s37, s31
    s_mov_b32 s38, 2097152
    s_mov_b32 s39, 0x00020000
    s_lshr_b32 s60, s2, 3
    s_and_b32 s61, s2, 7
    s_lshl_b32 s62, s61, 18
    s_lshl_b32 s63, s60, 7
    s_add_u32 s62, s62, s63
    v_lshlrev_b32 v17, 13, v13
    v_lshl_add_u32 v17, v12, 4, v17
    v_add_u32 v17, s62, v17
    buffer_store_dwordx4 v[236:239], v17, s[36:39], 0 offen sc1
    s_nop 1
    v_add_u32 v17, 4096, v17
    buffer_store_dwordx4 v[240:243], v17, s[36:39], 0 offen sc1
    s_mov_b32 s62, 0x3f803f80
    v_mov_b32 v4, 0
    v_mov_b32 v5, 0
    v_dot2_f32_bf16 v4, v100, s62, v4
    v_dot2_f32_bf16 v5, v100, v100, v5
    v_dot2_f32_bf16 v4, v101, s62, v4
    v_dot2_f32_bf16 v5, v101, v101, v5
    v_dot2_f32_bf16 v4, v102, s62, v4
    v_dot2_f32_bf16 v5, v102, v102, v5
    v_dot2_f32_bf16 v4, v103, s62, v4
    v_dot2_f32_bf16 v5, v103, v103, v5
    v_dot2_f32_bf16 v4, v104, s62, v4
    v_dot2_f32_bf16 v5, v104, v104, v5
    v_dot2_f32_bf16 v4, v105, s62, v4
    v_dot2_f32_bf16 v5, v105, v105, v5
    v_dot2_f32_bf16 v4, v106, s62, v4
    v_dot2_f32_bf16 v5, v106, v106, v5
    v_dot2_f32_bf16 v4, v107, s62, v4
    v_dot2_f32_bf16 v5, v107, v107, v5
    s_nop 1
    v_add_f32_dpp v6, v4, v4 quad_perm:[1,0,3,2] row_mask:0xf bank_mask:0xf
    s_nop 1
    v_add_f32_dpp v4, v6, v6 quad_perm:[2,3,0,1] row_mask:0xf bank_mask:0xf
    s_nop 1
    v_add_f32_dpp v6, v4, v4 row_half_mirror row_mask:0xf bank_mask:0xf
    s_nop 1
    v_add_f32_dpp v4, v6, v6 row_mirror row_mask:0xf bank_mask:0xf
    v_mov_b32 v6, v4
    s_nop 1
    v_permlane16_swap_b32 v4, v6
    v_add_f32 v4, v4, v6
    s_nop 0
    v_add_f32_dpp v6, v5, v5 quad_perm:[1,0,3,2] row_mask:0xf bank_mask:0xf
    s_nop 1
    v_add_f32_dpp v5, v6, v6 quad_perm:[2,3,0,1] row_mask:0xf bank_mask:0xf
    s_nop 1
    v_add_f32_dpp v6, v5, v5 row_half_mirror row_mask:0xf bank_mask:0xf
    s_nop 1
    v_add_f32_dpp v5, v6, v6 row_mirror row_mask:0xf bank_mask:0xf
    v_mov_b32 v6, v5
    s_nop 1
    v_permlane16_swap_b32 v5, v6
    v_add_f32 v5, v5, v6
    v_mul_f32 v4, 0x3b000000, v4
    v_mul_f32 v5, 0x3b000000, v5
    v_fma_f32 v5, -v4, v4, v5
    v_max_f32 v5, 0, v5
    v_cvt_pk_bf16_f32 v5, v5, v5
    v_lshlrev_b32 v5, 16, v5
    v_add_f32 v5, 0x3727c5ac, v5
    v_cvt_pk_bf16_f32 v5, v5, v5
    v_lshlrev_b32 v5, 16, v5
    v_sqrt_f32 v5, v5
    s_nop 0
    v_cvt_pk_bf16_f32 v6, v4, v5
    s_waitcnt vmcnt(10)
    v_readfirstlane_b32 s33, v55
    s_nop 0
    s_cmp_lg_u32 s33, 0
    s_cbranch_scc1 L_nonce_ok_2
    s_mov_b32 s60, 0
L_nonce_1:
    s_sleep 1
    global_load_dword v55, v54, s[28:29] sc1
    s_add_u32 s60, s60, 1
    s_waitcnt vmcnt(0)
    v_readfirstlane_b32 s33, v55
    s_cmp_gt_u32 s60, 20000
    s_cbranch_scc1 L_nonce_ok_2
    s_cmp_eq_u32 s33, 0
    s_cbranch_scc1 L_nonce_1
L_nonce_ok_2:
    v_mov_b32 v7, s33
    s_add_u32 s44, s30, 12582912
    s_addc_u32 s45, s31, 0
    s_mov_b32 s46, 16384
    s_mov_b32 s47, 0x00020000
    s_and_b32 s62, s2, 7
    s_lshl_b32 s62, s62, 8
    s_lshr_b32 s63, s2, 3
    s_lshl_b32 s63, s63, 3
    s_add_u32 s62, s62, s63
    s_lshl_b32 s63, s32, 1
    s_add_u32 s62, s62, s63
    v_lshrrev_b32 v8, 5, v1
    v_add_u32 v8, s62, v8
    v_lshlrev_b32 v8, 3, v8
    v_and_b32 v9, 31, v1
    v_cmp_eq_u32 vcc, 0, v9
    v_mov_b32 v9, 2146435072
    s_nop 0
    v_cndmask_b32 v8, v9, v8, vcc
    buffer_store_dwordx2 v[6:7], v8, s[44:47], 0 offen sc1
    v_lshrrev_b32 v8, 3, v1
    v_and_b32 v10, 7, v1
    v_bfe_u32 v9, v1, 4, 1
    v_lshlrev_b32 v9, 2, v9
    v_xor_b32 v11, v10, v9
    v_lshlrev_b32 v11, 4, v11
    v_lshl_add_u32 v24, v8, 10, v11
    s_lshr_b32 s60, s2, 5
    s_mul_i32 s61, s32, 458752
    s_lshl_b32 s60, s60, 7
    s_add_u32 s60, s60, s61
    v_add_u32 v24, s60, v24
    v_add_u32 v25, 8192, v24
    buffer_load_ushort v108, v98, s[56:59], 0 offen
    buffer_load_ushort v109, v98, s[56:59], 0 offen offset:64
    s_mov_b32 s44, s14
    s_mov_b32 s45, s15
    s_mov_b32 s46, 1024
    s_mov_b32 s47, 0x00020000
    s_lshl_b32 s60, s73, 1
    v_mov_b32 v4, s60
    buffer_load_ushort v60, v4, s[44:47], 0 offen
    s_mov_b32 s44, s24
    s_mov_b32 s45, s25
    s_mov_b32 s46, 1024
    s_mov_b32 s47, 0x00020000
    s_lshr_b32 s60, s2, 5
    s_lshl_b32 s60, s60, 7
    s_lshr_b32 s61, s32, 1
    s_lshl_b32 s61, s61, 6
    s_add_u32 s60, s60, s61
    v_lshrrev_b32 v4, 5, v1
    v_lshlrev_b32 v4, 3, v4
    v_add_u32 v4, s60, v4
    buffer_load_dwordx2 v[244:245], v4, s[44:47], 0 offen offset:0
    buffer_load_dwordx2 v[246:247], v4, s[44:47], 0 offen offset:16
    buffer_load_dwordx2 v[248:249], v4, s[44:47], 0 offen offset:32
    buffer_load_dwordx2 v[250:251], v4, s[44:47], 0 offen offset:48
    s_waitcnt vmcnt(20)
    s_barrier
    ds_read_b64_tr_b16 v[64:65], v120 offset:0
    ds_read_b64_tr_b16 v[66:67], v120 offset:1024
    ds_read_b64_tr_b16 v[68:69], v121 offset:0
    ds_read_b64_tr_b16 v[70:71], v121 offset:1024
    ds_read_b128 v[72:75], v112 offset:0
    ds_read_b128 v[76:79], v112 offset:4096
    s_waitcnt lgkmcnt(0)
    v_mfma_f32_32x32x16_bf16 v[128:143], v[64:67], v[72:75], v[128:143]
    ds_read_b64_tr_b16 v[80:81], v120 offset:4096
    ds_read_b64_tr_b16 v[82:83], v120 offset:5120
    v_mfma_f32_32x32x16_bf16 v[144:159], v[64:67], v[76:79], v[144:159]
    ds_read_b64_tr_b16 v[84:85], v121 offset:4096
    ds_read_b64_tr_b16 v[86:87], v121 offset:5120
    s_add_u32 m0, s68, 65536
    s_nop 0
    buffer_load_dwordx4 v44, s[48:51], s69 offen lds
    v_mfma_f32_32x32x16_bf16 v[160:175], v[68:71], v[72:75], v[160:175]
    ds_read_b128 v[88:91], v113 offset:0
    ds_read_b128 v[92:95], v113 offset:4096
    s_add_u32 m0, s68, 66560
    s_nop 0
    buffer_load_dwordx4 v45, s[48:51], s69 offen lds
    v_mfma_f32_32x32x16_bf16 v[176:191], v[68:71], v[76:79], v[176:191]
    s_add_u32 m0, s68, 67584
    s_nop 0
    buffer_load_dwordx4 v46, s[48:51], s69 offen lds
    s_waitcnt lgkmcnt(0)
    v_mfma_f32_32x32x16_bf16 v[128:143], v[80:83], v[88:91], v[128:143]
    ds_read_b64_tr_b16 v[64:65], v120 offset:8192
    ds_read_b64_tr_b16 v[66:67], v120 offset:9216
    v_mfma_f32_32x32x16_bf16 v[144:159], v[80:83], v[92:95], v[144:159]
    ds_read_b64_tr_b16 v[68:69], v121 offset:8192
    ds_read_b64_tr_b16 v[70:71], v121 offset:9216
    s_add_u32 m0, s68, 68608
    s_nop 0
    buffer_load_dwordx4 v47, s[48:51], s69 offen lds
    v_mfma_f32_32x32x16_bf16 v[160:175], v[84:87], v[88:91], v[160:175]
    ds_read_b128 v[72:75], v114 offset:0
    ds_read_b128 v[76:79], v114 offset:4096
    s_add_u32 m0, s68, 81920
    s_nop 0
    buffer_load_dwordx4 v48, s[52:55], s70 offen lds
    v_mfma_f32_32x32x16_bf16 v[176:191], v[84:87], v[92:95], v[176:191]
    s_add_u32 m0, s68, 82944
    s_nop 0
    buffer_load_dwordx4 v49, s[52:55], s70 offen lds
    s_waitcnt lgkmcnt(0)
    v_mfma_f32_32x32x16_bf16 v[128:143], v[64:67], v[72:75], v[128:143]
    ds_read_b64_tr_b16 v[80:81], v120 offset:12288
    ds_read_b64_tr_b16 v[82:83], v120 offset:13312
    v_mfma_f32_32x32x16_bf16 v[144:159], v[64:67], v[76:79], v[144:159]
    ds_read_b64_tr_b16 v[84:85], v121 offset:12288
    ds_read_b64_tr_b16 v[86:87], v121 offset:13312
    s_add_u32 m0, s68, 83968
    s_nop 0
    buffer_load_dwordx4 v50, s[52:55], s70 offen lds
    v_mfma_f32_32x32x16_bf16 v[160:175], v[68:71], v[72:75], v[160:175]
    ds_read_b128 v[88:91], v115 offset:0
    ds_read_b128 v[92:95], v115 offset:4096
    v_mfma_f32_32x32x16_bf16 v[176:191], v[68:71], v[76:79], v[176:191]
    s_add_u32 m0, s68, 84992
    s_nop 0
    buffer_load_dwordx4 v51, s[52:55], s70 offen lds
    s_add_u32 s69, s69, 128
    s_add_u32 s70, s70, 229376
    s_waitcnt vmcnt(18)
    s_barrier
    s_waitcnt lgkmcnt(0)
    v_mfma_f32_32x32x16_bf16 v[128:143], v[80:83], v[88:91], v[128:143]
    ds_read_b64_tr_b16 v[64:65], v120 offset:32768
    ds_read_b64_tr_b16 v[66:67], v120 offset:33792
    v_mfma_f32_32x32x16_bf16 v[144:159], v[80:83], v[92:95], v[144:159]
    ds_read_b64_tr_b16 v[68:69], v121 offset:32768
    ds_read_b64_tr_b16 v[70:71], v121 offset:33792
    s_add_u32 m0, s68, 98304
    s_nop 0
    buffer_load_dwordx4 v44, s[48:51], s69 offen lds
    v_mfma_f32_32x32x16_bf16 v[160:175], v[84:87], v[88:91], v[160:175]
    ds_read_b128 v[72:75], v112 offset:32768
    ds_read_b128 v[76:79], v112 offset:36864
    v_mfma_f32_32x32x16_bf16 v[176:191], v[84:87], v[92:95], v[176:191]
    s_add_u32 m0, s68, 99328
    s_nop 0
    buffer_load_dwordx4 v45, s[48:51], s69 offen lds
    s_waitcnt lgkmcnt(0)
    v_mfma_f32_32x32x16_bf16 v[128:143], v[64:67], v[72:75], v[128:143]
    ds_read_b64_tr_b16 v[80:81], v120 offset:36864
    ds_read_b64_tr_b16 v[82:83], v120 offset:37888
    v_mfma_f32_32x32x16_bf16 v[144:159], v[64:67], v[76:79], v[144:159]
    ds_read_b64_tr_b16 v[84:85], v121 offset:36864
    ds_read_b64_tr_b16 v[86:87], v121 offset:37888
    s_add_u32 m0, s68, 100352
    s_nop 0
    buffer_load_dwordx4 v46, s[48:51], s69 offen lds
    v_mfma_f32_32x32x16_bf16 v[160:175], v[68:71], v[72:75], v[160:175]
    ds_read_b128 v[88:91], v113 offset:32768
    ds_read_b128 v[92:95], v113 offset:36864
    v_mfma_f32_32x32x16_bf16 v[176:191], v[68:71], v[76:79], v[176:191]
    s_add_u32 m0, s68, 101376
    s_nop 0
    buffer_load_dwordx4 v47, s[48:51], s69 offen lds
    s_waitcnt lgkmcnt(0)
    v_mfma_f32_32x32x16_bf16 v[128:143], v[80:83], v[88:91], v[128:143]
    ds_read_b64_tr_b16 v[64:65], v120 offset:40960
    ds_read_b64_tr_b16 v[66:67], v120 offset:41984
    v_mfma_f32_32x32x16_bf16 v[144:159], v[80:83], v[92:95], v[144:159]
    ds_read_b64_tr_b16 v[68:69], v121 offset:40960
    ds_read_b64_tr_b16 v[70:71], v121 offset:41984
    s_add_u32 m0, s68, 114688
    s_nop 0
    buffer_load_dwordx4 v48, s[52:55], s70 offen lds
    v_mfma_f32_32x32x16_bf16 v[160:175], v[84:87], v[88:91], v[160:175]
    ds_read_b128 v[72:75], v114 offset:32768
    ds_read_b128 v[76:79], v114 offset:36864
    v_mfma_f32_32x32x16_bf16 v[176:191], v[84:87], v[92:95], v[176:191]
    s_add_u32 m0, s68, 115712
    s_nop 0
    buffer_load_dwordx4 v49, s[52:55], s70 offen lds
    s_waitcnt lgkmcnt(0)
    v_mfma_f32_32x32x16_bf16 v[128:143], v[64:67], v[72:75], v[128:143]
    ds_read_b64_tr_b16 v[80:81], v120 offset:45056
    ds_read_b64_tr_b16 v[82:83], v120 offset:46080
    v_mfma_f32_32x32x16_bf16 v[144:159], v[64:67], v[76:79], v[144:159]
    ds_read_b64_tr_b16 v[84:85], v121 offset:45056
    ds_read_b64_tr_b16 v[86:87], v121 offset:46080
    s_add_u32 m0, s68, 116736
    s_nop 0
    buffer_load_dwordx4 v50, s[52:55], s70 offen lds
    v_mfma_f32_32x32x16_bf16 v[160:175], v[68:71], v[72:75], v[160:175]
    ds_read_b128 v[88:91], v115 offset:32768
    ds_read_b128 v[92:95], v115 offset:36864
    v_mfma_f32_32x32x16_bf16 v[176:191], v[68:71], v[76:79], v[176:191]
    s_add_u32 m0, s68, 117760
    s_nop 0
    buffer_load_dwordx4 v51, s[52:55], s70 offen lds
    s_add_u32 s69, s69, 128
    s_add_u32 s70, s70, 229376
    s_waitcnt vmcnt(8)
    s_barrier
    s_waitcnt lgkmcnt(0)
    v_mfma_f32_32x32x16_bf16 v[128:143], v[80:83], v[88:91], v[128:143]
    ds_read_b64_tr_b16 v[64:65], v122 offset:0
    ds_read_b64_tr_b16 v[66:67], v122 offset:1024
    v_mfma_f32_32x32x16_bf16 v[144:159], v[80:83], v[92:95], v[144:159]
    ds_read_b64_tr_b16 v[68:69], v123 offset:0
    ds_read_b64_tr_b16 v[70:71], v123 offset:1024
    s_add_u32 m0, s68, 0
    s_nop 0
    buffer_load_dwordx4 v44, s[48:51], s69 offen lds
    v_mfma_f32_32x32x16_bf16 v[160:175], v[84:87], v[88:91], v[160:175]
    ds_read_b128 v[72:75], v116 offset:0
    ds_read_b128 v[76:79], v116 offset:4096
    v_mfma_f32_32x32x16_bf16 v[176:191], v[84:87], v[92:95], v[176:191]
    s_add_u32 m0, s68, 1024
    s_nop 0
    buffer_load_dwordx4 v45, s[48:51], s69 offen lds
    s_waitcnt lgkmcnt(0)
    v_mfma_f32_32x32x16_bf16 v[128:143], v[64:67], v[72:75], v[128:143]
    ds_read_b64_tr_b16 v[80:81], v122 offset:4096
    ds_read_b64_tr_b16 v[82:83], v122 offset:5120
    v_mfma_f32_32x32x16_bf16 v[144:159], v[64:67], v[76:79], v[144:159]
    ds_read_b64_tr_b16 v[84:85], v123 offset:4096
    ds_read_b64_tr_b16 v[86:87], v123 offset:5120
    s_add_u32 m0, s68, 2048
    s_nop 0
    buffer_load_dwordx4 v46, s[48:51], s69 offen lds
    v_mfma_f32_32x32x16_bf16 v[160:175], v[68:71], v[72:75], v[160:175]
    ds_read_b128 v[88:91], v117 offset:0
    ds_read_b128 v[92:95], v117 offset:4096
    v_mfma_f32_32x32x16_bf16 v[176:191], v[68:71], v[76:79], v[176:191]
    s_add_u32 m0, s68, 3072
    s_nop 0
    buffer_load_dwordx4 v47, s[48:51], s69 offen lds
    s_waitcnt lgkmcnt(0)
    v_mfma_f32_32x32x16_bf16 v[128:143], v[80:83], v[88:91], v[128:143]
    ds_read_b64_tr_b16 v[64:65], v122 offset:8192
    ds_read_b64_tr_b16 v[66:67], v122 offset:9216
    v_mfma_f32_32x32x16_bf16 v[144:159], v[80:83], v[92:95], v[144:159]
    ds_read_b64_tr_b16 v[68:69], v123 offset:8192
    ds_read_b64_tr_b16 v[70:71], v123 offset:9216
    s_add_u32 m0, s68, 16384
    s_nop 0
    buffer_load_dwordx4 v48, s[52:55], s70 offen lds
    v_mfma_f32_32x32x16_bf16 v[160:175], v[84:87], v[88:91], v[160:175]
    ds_read_b128 v[72:75], v118 offset:0
    ds_read_b128 v[76:79], v118 offset:4096
    v_mfma_f32_32x32x16_bf16 v[176:191], v[84:87], v[92:95], v[176:191]
    s_add_u32 m0, s68, 17408
    s_nop 0
    buffer_load_dwordx4 v49, s[52:55], s70 offen lds
    s_waitcnt lgkmcnt(0)
    v_mfma_f32_32x32x16_bf16 v[128:143], v[64:67], v[72:75], v[128:143]
    ds_read_b64_tr_b16 v[80:81], v122 offset:12288
    ds_read_b64_tr_b16 v[82:83], v122 offset:13312
    v_mfma_f32_32x32x16_bf16 v[144:159], v[64:67], v[76:79], v[144:159]
    ds_read_b64_tr_b16 v[84:85], v123 offset:12288
    ds_read_b64_tr_b16 v[86:87], v123 offset:13312
    s_add_u32 m0, s68, 18432
    s_nop 0
    buffer_load_dwordx4 v50, s[52:55], s70 offen lds
    v_mfma_f32_32x32x16_bf16 v[160:175], v[68:71], v[72:75], v[160:175]
    ds_read_b128 v[88:91], v119 offset:0
    ds_read_b128 v[92:95], v119 offset:4096
    v_mfma_f32_32x32x16_bf16 v[176:191], v[68:71], v[76:79], v[176:191]
    s_add_u32 m0, s68, 19456
    s_nop 0
    buffer_load_dwordx4 v51, s[52:55], s70 offen lds
    s_add_u32 s69, s69, 128
    s_add_u32 s70, s70, 229376
    s_waitcnt vmcnt(8)
    s_barrier
    s_waitcnt lgkmcnt(0)
    v_mfma_f32_32x32x16_bf16 v[128:143], v[80:83], v[88:91], v[128:143]
    ds_read_b64_tr_b16 v[64:65], v122 offset:32768
    ds_read_b64_tr_b16 v[66:67], v122 offset:33792
    v_mfma_f32_32x32x16_bf16 v[144:159], v[80:83], v[92:95], v[144:159]
    ds_read_b64_tr_b16 v[68:69], v123 offset:32768
    ds_read_b64_tr_b16 v[70:71], v123 offset:33792
    s_add_u32 m0, s68, 32768
    s_nop 0
    buffer_load_dwordx4 v44, s[48:51], s69 offen lds
    v_mfma_f32_32x32x16_bf16 v[160:175], v[84:87], v[88:91], v[160:175]
    ds_read_b128 v[72:75], v116 offset:32768
    ds_read_b128 v[76:79], v116 offset:36864
    v_mfma_f32_32x32x16_bf16 v[176:191], v[84:87], v[92:95], v[176:191]
    s_add_u32 m0, s68, 33792
    s_nop 0
    buffer_load_dwordx4 v45, s[48:51], s69 offen lds
    s_waitcnt lgkmcnt(0)
    v_mfma_f32_32x32x16_bf16 v[128:143], v[64:67], v[72:75], v[128:143]
    ds_read_b64_tr_b16 v[80:81], v122 offset:36864
    ds_read_b64_tr_b16 v[82:83], v122 offset:37888
    v_mfma_f32_32x32x16_bf16 v[144:159], v[64:67], v[76:79], v[144:159]
    ds_read_b64_tr_b16 v[84:85], v123 offset:36864
    ds_read_b64_tr_b16 v[86:87], v123 offset:37888
    s_add_u32 m0, s68, 34816
    s_nop 0
    buffer_load_dwordx4 v46, s[48:51], s69 offen lds
    v_mfma_f32_32x32x16_bf16 v[160:175], v[68:71], v[72:75], v[160:175]
    ds_read_b128 v[88:91], v117 offset:32768
    ds_read_b128 v[92:95], v117 offset:36864
    v_mfma_f32_32x32x16_bf16 v[176:191], v[68:71], v[76:79], v[176:191]
    s_add_u32 m0, s68, 35840
    s_nop 0
    buffer_load_dwordx4 v47, s[48:51], s69 offen lds
    s_waitcnt lgkmcnt(0)
    v_mfma_f32_32x32x16_bf16 v[128:143], v[80:83], v[88:91], v[128:143]
    ds_read_b64_tr_b16 v[64:65], v122 offset:40960
    ds_read_b64_tr_b16 v[66:67], v122 offset:41984
    v_mfma_f32_32x32x16_bf16 v[144:159], v[80:83], v[92:95], v[144:159]
    ds_read_b64_tr_b16 v[68:69], v123 offset:40960
    ds_read_b64_tr_b16 v[70:71], v123 offset:41984
    s_add_u32 m0, s68, 49152
    s_nop 0
    buffer_load_dwordx4 v48, s[52:55], s70 offen lds
    v_mfma_f32_32x32x16_bf16 v[160:175], v[84:87], v[88:91], v[160:175]
    ds_read_b128 v[72:75], v118 offset:32768
    ds_read_b128 v[76:79], v118 offset:36864
    v_mfma_f32_32x32x16_bf16 v[176:191], v[84:87], v[92:95], v[176:191]
    s_add_u32 m0, s68, 50176
    s_nop 0
    buffer_load_dwordx4 v49, s[52:55], s70 offen lds
    s_waitcnt lgkmcnt(0)
    v_mfma_f32_32x32x16_bf16 v[128:143], v[64:67], v[72:75], v[128:143]
    ds_read_b64_tr_b16 v[80:81], v122 offset:45056
    ds_read_b64_tr_b16 v[82:83], v122 offset:46080
    v_mfma_f32_32x32x16_bf16 v[144:159], v[64:67], v[76:79], v[144:159]
    ds_read_b64_tr_b16 v[84:85], v123 offset:45056
    ds_read_b64_tr_b16 v[86:87], v123 offset:46080
    s_add_u32 m0, s68, 51200
    s_nop 0
    buffer_load_dwordx4 v50, s[52:55], s70 offen lds
    v_mfma_f32_32x32x16_bf16 v[160:175], v[68:71], v[72:75], v[160:175]
    ds_read_b128 v[88:91], v119 offset:32768
    ds_read_b128 v[92:95], v119 offset:36864
    v_mfma_f32_32x32x16_bf16 v[176:191], v[68:71], v[76:79], v[176:191]
    s_add_u32 m0, s68, 52224
    s_nop 0
    buffer_load_dwordx4 v51, s[52:55], s70 offen lds
    s_add_u32 s69, s69, 128
    s_add_u32 s70, s70, 229376
    s_waitcnt vmcnt(8)
    s_barrier
    s_lshl_b32 s61, s2, 7
    s_add_u32 s61, s61, 32768
    s_cmp_lg_u32 s32, 0
    s_cbranch_scc1 L_fs_3
    v_mov_b32 v4, s61
    v_mov_b32 v5, s33
    s_mov_b64 exec, 1
    buffer_store_dword v5, v4, s[76:79], 0 offen sc1
    s_mov_b64 exec, -1
L_fs_3:
    s_waitcnt lgkmcnt(0)
    v_mfma_f32_32x32x16_bf16 v[128:143], v[80:83], v[88:91], v[128:143]
    ds_read_b64_tr_b16 v[64:65], v120 offset:0
    ds_read_b64_tr_b16 v[66:67], v120 offset:1024
    v_mfma_f32_32x32x16_bf16 v[144:159], v[80:83], v[92:95], v[144:159]
    ds_read_b64_tr_b16 v[68:69], v121 offset:0
    ds_read_b64_tr_b16 v[70:71], v121 offset:1024
    s_add_u32 m0, s68, 65536
    s_nop 0
    buffer_load_dwordx4 v44, s[48:51], s69 offen lds
    v_mfma_f32_32x32x16_bf16 v[160:175], v[84:87], v[88:91], v[160:175]
    ds_read_b128 v[72:75], v112 offset:0
    ds_read_b128 v[76:79], v112 offset:4096
    v_mfma_f32_32x32x16_bf16 v[176:191], v[84:87], v[92:95], v[176:191]
    s_add_u32 m0, s68, 66560
    s_nop 0
    buffer_load_dwordx4 v45, s[48:51], s69 offen lds
    s_waitcnt lgkmcnt(0)
    v_mfma_f32_32x32x16_bf16 v[128:143], v[64:67], v[72:75], v[128:143]
    ds_read_b64_tr_b16 v[80:81], v120 offset:4096
    ds_read_b64_tr_b16 v[82:83], v120 offset:5120
    v_mfma_f32_32x32x16_bf16 v[144:159], v[64:67], v[76:79], v[144:159]
    ds_read_b64_tr_b16 v[84:85], v121 offset:4096
    ds_read_b64_tr_b16 v[86:87], v121 offset:5120
    s_add_u32 m0, s68, 67584
    s_nop 0
    buffer_load_dwordx4 v46, s[48:51], s69 offen lds
    v_mfma_f32_32x32x16_bf16 v[160:175], v[68:71], v[72:75], v[160:175]
    ds_read_b128 v[88:91], v113 offset:0
    ds_read_b128 v[92:95], v113 offset:4096
    v_mfma_f32_32x32x16_bf16 v[176:191], v[68:71], v[76:79], v[176:191]
    s_add_u32 m0, s68, 68608
    s_nop 0
    buffer_load_dwordx4 v47, s[48:51], s69 offen lds
    s_waitcnt lgkmcnt(0)
    v_mfma_f32_32x32x16_bf16 v[128:143], v[80:83], v[88:91], v[128:143]
    ds_read_b64_tr_b16 v[64:65], v120 offset:8192
    ds_read_b64_tr_b16 v[66:67], v120 offset:9216
    v_mfma_f32_32x32x16_bf16 v[144:159], v[80:83], v[92:95], v[144:159]
    ds_read_b64_tr_b16 v[68:69], v121 offset:8192
    ds_read_b64_tr_b16 v[70:71], v121 offset:9216
    s_add_u32 m0, s68, 81920
    s_nop 0
    buffer_load_dwordx4 v48, s[52:55], s70 offen lds
    v_mfma_f32_32x32x16_bf16 v[160:175], v[84:87], v[88:91], v[160:175]
    ds_read_b128 v[72:75], v114 offset:0
    ds_read_b128 v[76:79], v114 offset:4096
    v_mfma_f32_32x32x16_bf16 v[176:191], v[84:87], v[92:95], v[176:191]
    s_add_u32 m0, s68, 82944
    s_nop 0
    buffer_load_dwordx4 v49, s[52:55], s70 offen lds
    s_waitcnt lgkmcnt(0)
    v_mfma_f32_32x32x16_bf16 v[128:143], v[64:67], v[72:75], v[128:143]
    ds_read_b64_tr_b16 v[80:81], v120 offset:12288
    ds_read_b64_tr_b16 v[82:83], v120 offset:13312
    v_mfma_f32_32x32x16_bf16 v[144:159], v[64:67], v[76:79], v[144:159]
    ds_read_b64_tr_b16 v[84:85], v121 offset:12288
    ds_read_b64_tr_b16 v[86:87], v121 offset:13312
    s_add_u32 m0, s68, 83968
    s_nop 0
    buffer_load_dwordx4 v50, s[52:55], s70 offen lds
    v_mfma_f32_32x32x16_bf16 v[160:175], v[68:71], v[72:75], v[160:175]
    ds_read_b128 v[88:91], v115 offset:0
    ds_read_b128 v[92:95], v115 offset:4096
    v_mfma_f32_32x32x16_bf16 v[176:191], v[68:71], v[76:79], v[176:191]
    s_add_u32 m0, s68, 84992
    s_nop 0
    buffer_load_dwordx4 v51, s[52:55], s70 offen lds
    s_add_u32 s69, s69, 128
    s_add_u32 s70, s70, 229376
    s_waitcnt vmcnt(8)
    s_barrier
    s_waitcnt lgkmcnt(0)
    v_mfma_f32_32x32x16_bf16 v[128:143], v[80:83], v[88:91], v[128:143]
    ds_read_b64_tr_b16 v[64:65], v120 offset:32768
    ds_read_b64_tr_b16 v[66:67], v120 offset:33792
    v_mfma_f32_32x32x16_bf16 v[144:159], v[80:83], v[92:95], v[144:159]
    ds_read_b64_tr_b16 v[68:69], v121 offset:32768
    ds_read_b64_tr_b16 v[70:71], v121 offset:33792
    s_add_u32 m0, s68, 98304
    s_nop 0
    buffer_load_dwordx4 v44, s[48:51], s69 offen lds
    v_mfma_f32_32x32x16_bf16 v[160:175], v[84:87], v[88:91], v[160:175]
    ds_read_b128 v[72:75], v112 offset:32768
    ds_read_b128 v[76:79], v112 offset:36864
    v_mfma_f32_32x32x16_bf16 v[176:191], v[84:87], v[92:95], v[176:191]
    s_add_u32 m0, s68, 99328
    s_nop 0
    buffer_load_dwordx4 v45, s[48:51], s69 offen lds
    s_waitcnt lgkmcnt(0)
    v_mfma_f32_32x32x16_bf16 v[128:143], v[64:67], v[72:75], v[128:143]
    ds_read_b64_tr_b16 v[80:81], v120 offset:36864
    ds_read_b64_tr_b16 v[82:83], v120 offset:37888
    v_mfma_f32_32x32x16_bf16 v[144:159], v[64:67], v[76:79], v[144:159]
    ds_read_b64_tr_b16 v[84:85], v121 offset:36864
    ds_read_b64_tr_b16 v[86:87], v121 offset:37888
    s_add_u32 m0, s68, 100352
    s_nop 0
    buffer_load_dwordx4 v46, s[48:51], s69 offen lds
    v_mfma_f32_32x32x16_bf16 v[160:175], v[68:71], v[72:75], v[160:175]
    ds_read_b128 v[88:91], v113 offset:32768
    ds_read_b128 v[92:95], v113 offset:36864
    v_mfma_f32_32x32x16_bf16 v[176:191], v[68:71], v[76:79], v[176:191]
    s_add_u32 m0, s68, 101376
    s_nop 0
    buffer_load_dwordx4 v47, s[48:51], s69 offen lds
    s_waitcnt lgkmcnt(0)
    v_mfma_f32_32x32x16_bf16 v[128:143], v[80:83], v[88:91], v[128:143]
    ds_read_b64_tr_b16 v[64:65], v120 offset:40960
    ds_read_b64_tr_b16 v[66:67], v120 offset:41984
    v_mfma_f32_32x32x16_bf16 v[144:159], v[80:83], v[92:95], v[144:159]
    ds_read_b64_tr_b16 v[68:69], v121 offset:40960
    ds_read_b64_tr_b16 v[70:71], v121 offset:41984
    s_add_u32 m0, s68, 114688
    s_nop 0
    buffer_load_dwordx4 v48, s[52:55], s70 offen lds
    v_mfma_f32_32x32x16_bf16 v[160:175], v[84:87], v[88:91], v[160:175]
    ds_read_b128 v[72:75], v114 offset:32768
    ds_read_b128 v[76:79], v114 offset:36864
    v_mfma_f32_32x32x16_bf16 v[176:191], v[84:87], v[92:95], v[176:191]
    s_add_u32 m0, s68, 115712
    s_nop 0
    buffer_load_dwordx4 v49, s[52:55], s70 offen lds
    s_waitcnt lgkmcnt(0)
    v_mfma_f32_32x32x16_bf16 v[128:143], v[64:67], v[72:75], v[128:143]
    ds_read_b64_tr_b16 v[80:81], v120 offset:45056
    ds_read_b64_tr_b16 v[82:83], v120 offset:46080
    v_mfma_f32_32x32x16_bf16 v[144:159], v[64:67], v[76:79], v[144:159]
    ds_read_b64_tr_b16 v[84:85], v121 offset:45056
    ds_read_b64_tr_b16 v[86:87], v121 offset:46080
    s_add_u32 m0, s68, 116736
    s_nop 0
    buffer_load_dwordx4 v50, s[52:55], s70 offen lds
    v_mfma_f32_32x32x16_bf16 v[160:175], v[68:71], v[72:75], v[160:175]
    ds_read_b128 v[88:91], v115 offset:32768
    ds_read_b128 v[92:95], v115 offset:36864
    v_mfma_f32_32x32x16_bf16 v[176:191], v[68:71], v[76:79], v[176:191]
    s_add_u32 m0, s68, 117760
    s_nop 0
    buffer_load_dwordx4 v51, s[52:55], s70 offen lds
    s_add_u32 s69, s69, 128
    s_add_u32 s70, s70, 229376
    s_waitcnt vmcnt(8)
    s_barrier
    s_waitcnt lgkmcnt(0)
    v_mfma_f32_32x32x16_bf16 v[128:143], v[80:83], v[88:91], v[128:143]
    ds_read_b64_tr_b16 v[64:65], v122 offset:0
    ds_read_b64_tr_b16 v[66:67], v122 offset:1024
    v_mfma_f32_32x32x16_bf16 v[144:159], v[80:83], v[92:95], v[144:159]
    ds_read_b64_tr_b16 v[68:69], v123 offset:0
    ds_read_b64_tr_b16 v[70:71], v123 offset:1024
    v_mfma_f32_32x32x16_bf16 v[160:175], v[84:87], v[88:91], v[160:175]
    ds_read_b128 v[72:75], v116 offset:0
    ds_read_b128 v[76:79], v116 offset:4096
    v_mfma_f32_32x32x16_bf16 v[176:191], v[84:87], v[92:95], v[176:191]
    s_add_u32 s36, s12, s74
    s_addc_u32 s37, s13, 0
    s_mov_b32 s38, 4096
    s_mov_b32 s39, 0x00020000
    v_and_b32 v4, 127, v0
    v_lshlrev_b32 v5, 4, v4
    v_subrev_u32 v6, 32, v5
    v_subrev_u32 v7, 16, v5
    v_mov_b32 v8, 2146435072
    v_cmp_gt_u32 vcc, 2, v4
    s_nop 1
    v_cndmask_b32 v14, v6, v8, vcc
    v_cmp_gt_u32 vcc, 1, v4
    s_nop 1
    v_cndmask_b32 v15, v7, v8, vcc
    v_add_u32 v16, 2048, v6
    v_add_u32 v17, 2048, v7
    v_add_u32 v18, 4096, v6
    v_add_u32 v19, 4096, v7
    buffer_load_dwordx4 v[196:199], v14, s[36:39], 0 offen
    buffer_load_dwordx4 v[200:203], v15, s[36:39], 0 offen
    buffer_load_dwordx4 v[204:207], v16, s[36:39], 0 offen
    buffer_load_dwordx4 v[208:211], v17, s[36:39], 0 offen
    buffer_load_dwordx4 v[212:215], v18, s[36:39], 0 offen
    buffer_load_dwordx4 v[216:219], v19, s[36:39], 0 offen
    s_mov_b32 s48, s22
    s_mov_b32 s49, s23
    s_mov_b32 s50, 1835008
    s_mov_b32 s51, 0x00020000
    s_lshl_b32 s70, s32, 11
    s_add_u32 s70, s70, 42496
    s_mov_b32 s35, 0
    s_add_u32 m0, s70, 90112
    s_nop 0
    buffer_load_dwordx4 v24, s[48:51], s35 offen lds
    s_add_u32 m0, s70, 91136
    s_nop 0
    buffer_load_dwordx4 v25, s[48:51], s35 offen lds
    s_add_u32 s35, s35, 16384
    s_add_u32 m0, s70, 98304
    s_nop 0
    buffer_load_dwordx4 v24, s[48:51], s35 offen lds
    s_add_u32 m0, s70, 99328
    s_nop 0
    buffer_load_dwordx4 v25, s[48:51], s35 offen lds
    s_add_u32 s35, s35, 16384
    s_add_u32 m0, s70, 106496
    s_nop 0
    buffer_load_dwordx4 v24, s[48:51], s35 offen lds
    s_add_u32 m0, s70, 107520
    s_nop 0
    buffer_load_dwordx4 v25, s[48:51], s35 offen lds
    s_add_u32 s35, s35, 16384
    s_waitcnt lgkmcnt(0)
    v_mfma_f32_32x32x16_bf16 v[128:143], v[64:67], v[72:75], v[128:143]
    ds_read_b64_tr_b16 v[80:81], v122 offset:4096
    ds_read_b64_tr_b16 v[82:83], v122 offset:5120
    v_mfma_f32_32x32x16_bf16 v[144:159], v[64:67], v[76:79], v[144:159]
    ds_read_b64_tr_b16 v[84:85], v123 offset:4096
    ds_read_b64_tr_b16 v[86:87], v123 offset:5120
    v_mfma_f32_32x32x16_bf16 v[160:175], v[68:71], v[72:75], v[160:175]
    ds_read_b128 v[88:91], v117 offset:0
    ds_read_b128 v[92:95], v117 offset:4096
    v_mfma_f32_32x32x16_bf16 v[176:191], v[68:71], v[76:79], v[176:191]
    s_waitcnt lgkmcnt(0)
    v_mfma_f32_32x32x16_bf16 v[128:143], v[80:83], v[88:91], v[128:143]
    ds_read_b64_tr_b16 v[64:65], v122 offset:8192
    ds_read_b64_tr_b16 v[66:67], v122 offset:9216
    v_mfma_f32_32x32x16_bf16 v[144:159], v[80:83], v[92:95], v[144:159]
    ds_read_b64_tr_b16 v[68:69], v123 offset:8192
    ds_read_b64_tr_b16 v[70:71], v123 offset:9216
    v_mfma_f32_32x32x16_bf16 v[160:175], v[84:87], v[88:91], v[160:175]
    ds_read_b128 v[72:75], v118 offset:0
    ds_read_b128 v[76:79], v118 offset:4096
    v_mfma_f32_32x32x16_bf16 v[176:191], v[84:87], v[92:95], v[176:191]
    s_waitcnt lgkmcnt(0)
    v_mfma_f32_32x32x16_bf16 v[128:143], v[64:67], v[72:75], v[128:143]
    ds_read_b64_tr_b16 v[80:81], v122 offset:12288
    ds_read_b64_tr_b16 v[82:83], v122 offset:13312
    v_mfma_f32_32x32x16_bf16 v[144:159], v[64:67], v[76:79], v[144:159]
    ds_read_b64_tr_b16 v[84:85], v123 offset:12288
    ds_read_b64_tr_b16 v[86:87], v123 offset:13312
    v_mfma_f32_32x32x16_bf16 v[160:175], v[68:71], v[72:75], v[160:175]
    ds_read_b128 v[88:91], v119 offset:0
    ds_read_b128 v[92:95], v119 offset:4096
    v_mfma_f32_32x32x16_bf16 v[176:191], v[68:71], v[76:79], v[176:191]
    s_waitcnt vmcnt(10)
    s_barrier
    s_and_b32 s60, s2, 7
    s_add_u32 s60, s60, 256
    s_lshl_b32 s60, s60, 7
    v_and_b32 v61, 31, v1
    v_lshlrev_b32 v61, 10, v61
    v_add_u32 v61, s60, v61
    buffer_load_dword v62, v61, s[76:79], 0 offen sc1
    buffer_load_dwordx2 v[100:101], v97, s[40:43], 0 offen sc1
    buffer_load_dwordx2 v[102:103], v97, s[40:43], 0 offen offset:256 sc1
    buffer_load_dwordx2 v[104:105], v99, s[40:43], 0 offen sc1
    buffer_load_dwordx2 v[106:107], v99, s[40:43], 0 offen offset:256 sc1
    s_waitcnt lgkmcnt(0)
    v_mfma_f32_32x32x16_bf16 v[128:143], v[80:83], v[88:91], v[128:143]
    ds_read_b64_tr_b16 v[64:65], v122 offset:32768
    ds_read_b64_tr_b16 v[66:67], v122 offset:33792
    v_mfma_f32_32x32x16_bf16 v[144:159], v[80:83], v[92:95], v[144:159]
    ds_read_b64_tr_b16 v[68:69], v123 offset:32768
    ds_read_b64_tr_b16 v[70:71], v123 offset:33792
    v_mfma_f32_32x32x16_bf16 v[160:175], v[84:87], v[88:91], v[160:175]
    ds_read_b128 v[72:75], v116 offset:32768
    ds_read_b128 v[76:79], v116 offset:36864
    v_mfma_f32_32x32x16_bf16 v[176:191], v[84:87], v[92:95], v[176:191]
    s_waitcnt lgkmcnt(0)
    v_mfma_f32_32x32x16_bf16 v[128:143], v[64:67], v[72:75], v[128:143]
    ds_read_b64_tr_b16 v[80:81], v122 offset:36864
    ds_read_b64_tr_b16 v[82:83], v122 offset:37888
    v_mfma_f32_32x32x16_bf16 v[144:159], v[64:67], v[76:79], v[144:159]
    ds_read_b64_tr_b16 v[84:85], v123 offset:36864
    ds_read_b64_tr_b16 v[86:87], v123 offset:37888
    v_mfma_f32_32x32x16_bf16 v[160:175], v[68:71], v[72:75], v[160:175]
    ds_read_b128 v[88:91], v117 offset:32768
    ds_read_b128 v[92:95], v117 offset:36864
    v_mfma_f32_32x32x16_bf16 v[176:191], v[68:71], v[76:79], v[176:191]
    s_add_u32 m0, s70, 0
    s_nop 0
    buffer_load_dwordx4 v24, s[48:51], s35 offen lds
    s_add_u32 m0, s70, 1024
    s_nop 0
    buffer_load_dwordx4 v25, s[48:51], s35 offen lds
    s_add_u32 s35, s35, 16384
    s_waitcnt lgkmcnt(0)
    v_mfma_f32_32x32x16_bf16 v[128:143], v[80:83], v[88:91], v[128:143]
    ds_read_b64_tr_b16 v[64:65], v122 offset:40960
    ds_read_b64_tr_b16 v[66:67], v122 offset:41984
    v_mfma_f32_32x32x16_bf16 v[144:159], v[80:83], v[92:95], v[144:159]
    ds_read_b64_tr_b16 v[68:69], v123 offset:40960
    ds_read_b64_tr_b16 v[70:71], v123 offset:41984
    v_mfma_f32_32x32x16_bf16 v[160:175], v[84:87], v[88:91], v[160:175]
    ds_read_b128 v[72:75], v118 offset:32768
    ds_read_b128 v[76:79], v118 offset:36864
    v_mfma_f32_32x32x16_bf16 v[176:191], v[84:87], v[92:95], v[176:191]
    s_add_u32 m0, s70, 8192
    s_nop 0
    buffer_load_dwordx4 v24, s[48:51], s35 offen lds
    s_add_u32 m0, s70, 9216
    s_nop 0
    buffer_load_dwordx4 v25, s[48:51], s35 offen lds
    s_add_u32 s35, s35, 16384
    s_waitcnt lgkmcnt(0)
    v_mfma_f32_32x32x16_bf16 v[128:143], v[64:67], v[72:75], v[128:143]
    ds_read_b64_tr_b16 v[80:81], v122 offset:45056
    ds_read_b64_tr_b16 v[82:83], v122 offset:46080
    v_mfma_f32_32x32x16_bf16 v[144:159], v[64:67], v[76:79], v[144:159]
    ds_read_b64_tr_b16 v[84:85], v123 offset:45056
    ds_read_b64_tr_b16 v[86:87], v123 offset:46080
    v_mfma_f32_32x32x16_bf16 v[160:175], v[68:71], v[72:75], v[160:175]
    ds_read_b128 v[88:91], v119 offset:32768
    ds_read_b128 v[92:95], v119 offset:36864
    v_mfma_f32_32x32x16_bf16 v[176:191], v[68:71], v[76:79], v[176:191]
    s_waitcnt lgkmcnt(0)
    s_barrier
    v_mfma_f32_32x32x16_bf16 v[128:143], v[80:83], v[88:91], v[128:143]
    v_mfma_f32_32x32x16_bf16 v[144:159], v[80:83], v[92:95], v[144:159]
    v_mfma_f32_32x32x16_bf16 v[160:175], v[84:87], v[88:91], v[160:175]
    v_mfma_f32_32x32x16_bf16 v[176:191], v[84:87], v[92:95], v[176:191]
    s_waitcnt vmcnt(8)
    v_cmp_ne_u32 vcc, s33, v62
    s_cbranch_vccz L_f2_ok_4
    s_mov_b32 s60, 0
L_f2_spin_5:
    s_sleep 4
    buffer_load_dword v62, v61, s[76:79], 0 offen sc1
    s_add_u32 s60, s60, 1
    s_waitcnt vmcnt(0)
    v_cmp_ne_u32 vcc, s33, v62
    s_cmp_gt_u32 s60, 20000
    s_cbranch_scc1 L_f2_ok_4
    s_cbranch_vccnz L_f2_spin_5
L_f2_ok_4:
    s_add_u32 s36, s30, s74
    s_addc_u32 s37, s31, 0
    s_mov_b32 s38, 4096
    s_mov_b32 s39, 0x00020000
    s_lshl_b32 s60, s72, 11
    v_lshlrev_b32 v4, 4, v1
    v_add_u32 v4, s60, v4
    buffer_load_dwordx4 v[220:223], v4, s[36:39], 0 offen sc1
    buffer_load_dwordx4 v[224:227], v4, s[36:39], 0 offen offset:1024 sc1
    s_waitcnt vmcnt(6)
    v_cmp_ne_u32 vcc, s33, v101
    s_nop 0
    s_mov_b64 s[62:63], vcc
    v_cmp_ne_u32 vcc, s33, v103
    s_nop 0
    s_or_b64 s[62:63], vcc, s[62:63]
    v_cmp_ne_u32 vcc, s33, v105
    s_nop 0
    s_or_b64 s[62:63], vcc, s[62:63]
    v_cmp_ne_u32 vcc, s33, v107
    s_nop 0
    s_or_b64 vcc, vcc, s[62:63]
    s_cbranch_vccz L_stat_ok_6
    s_mov_b32 s60, 0
L_stat_spin_7:
    s_sleep 4
    buffer_load_dwordx2 v[100:101], v97, s[40:43], 0 offen sc1
    buffer_load_dwordx2 v[102:103], v97, s[40:43], 0 offen offset:256 sc1
    buffer_load_dwordx2 v[104:105], v99, s[40:43], 0 offen sc1
    buffer_load_dwordx2 v[106:107], v99, s[40:43], 0 offen offset:256 sc1
    s_add_u32 s60, s60, 1
    s_waitcnt vmcnt(0)
    v_cmp_ne_u32 vcc, s33, v101
    s_nop 0
    s_mov_b64 s[62:63], vcc
    v_cmp_ne_u32 vcc, s33, v103
    s_nop 0
    s_or_b64 s[62:63], vcc, s[62:63]
    v_cmp_ne_u32 vcc, s33, v105
    s_nop 0
    s_or_b64 s[62:63], vcc, s[62:63]
    v_cmp_ne_u32 vcc, s33, v107
    s_nop 0
    s_or_b64 vcc, vcc, s[62:63]
    s_cmp_gt_u32 s60, 20000
    s_cbranch_scc1 L_stat_ok_6
    s_cbranch_vccnz L_stat_spin_7
L_stat_ok_6:
    v_and_b32 v4, 0xffff, v100
    v_xor_b32 v4, 0x8000, v4
    v_lshl_or_b32 v72, v4, 16, v4
    v_lshrrev_b32 v73, 16, v100
    v_mov_b32 v74, 0
    v_mov_b32 v75, 0
    v_and_b32 v4, 0xffff, v102
    v_xor_b32 v4, 0x8000, v4
    v_lshl_or_b32 v76, v4, 16, v4
    v_lshrrev_b32 v77, 16, v102
    v_mov_b32 v78, 0
    v_mov_b32 v79, 0
    v_cmp_gt_u32 vcc, 32, v1
    v_cvt_pk_bf16_f32 v4, v104, v104
    v_lshlrev_b32 v4, 16, v4
    v_sub_f32 v5, v104, v4
    v_cvt_pk_bf16_f32 v4, v104, v5
    v_cndmask_b32 v64, 0, v4, vcc
    v_cndmask_b32 v65, 0, v108, vcc
    v_mov_b32 v66, 0
    v_mov_b32 v67, 0
    v_cvt_pk_bf16_f32 v4, v106, v106
    v_lshlrev_b32 v4, 16, v4
    v_sub_f32 v5, v106, v4
    v_cvt_pk_bf16_f32 v4, v106, v5
    v_cndmask_b32 v68, 0, v4, vcc
    v_cndmask_b32 v69, 0, v109, vcc
    v_mov_b32 v70, 0
    v_mov_b32 v71, 0
    v_mfma_f32_32x32x16_bf16 v[128:143], v[64:67], v[72:75], v[128:143]
    v_mfma_f32_32x32x16_bf16 v[144:159], v[64:67], v[76:79], v[144:159]
    v_mfma_f32_32x32x16_bf16 v[160:175], v[68:71], v[72:75], v[160:175]
    v_mfma_f32_32x32x16_bf16 v[176:191], v[68:71], v[76:79], v[176:191]
    s_add_u32 s44, s30, 4194304
    s_addc_u32 s45, s31, 0
    s_mov_b32 s46, 7340032
    s_mov_b32 s47, 0x00020000
    s_lshl_b32 s62, s64, 2
    s_lshl_b32 s63, s67, 1
    s_add_u32 s62, s62, s63
    s_mul_i32 s62, s62, 112
    s_lshl_b32 s63, s65, 3
    s_add_u32 s62, s62, s63
    s_lshl_b32 s63, s66, 2
    s_add_u32 s62, s62, s63
    s_lshl_b32 s62, s62, 10
    v_lshlrev_b32 v12, 4, v1
    v_add_u32 v12, s62, v12
    v_add_u32 v13, 114688, v12
    s_lshl_b32 s75, s64, 4
    s_add_u32 s75, s75, s65
    s_add_u32 s75, s75, 512
    s_mul_i32 s68, s71, 4608
    s_add_u32 s68, s68, 33792
    s_mul_i32 s69, s71, 16640
    v_and_b32 v4, 127, v0
    v_lshlrev_b32 v5, 4, v4
    v_add_u32 v35, s69, v5
    v_max_f32 v16, 0, v128
    v_max_f32 v17, 0, v129
    v_pk_mul_f32 v[128:129], v[128:129], v[16:17]
    v_cvt_pk_bf16_f32 v80, v128, v129
    ds_write_b128 v35, v[196:199] offset:0
    v_max_f32 v16, 0, v130
    v_max_f32 v17, 0, v131
    v_pk_mul_f32 v[130:131], v[130:131], v[16:17]
    v_cvt_pk_bf16_f32 v81, v130, v131
    v_alignbit_b32 v40, v197, v196, 16
    v_max_f32 v16, 0, v132
    v_max_f32 v17, 0, v133
    v_pk_mul_f32 v[132:133], v[132:133], v[16:17]
    v_cvt_pk_bf16_f32 v82, v132, v133
    v_alignbit_b32 v41, v198, v197, 16
    v_max_f32 v16, 0, v134
    v_max_f32 v17, 0, v135
    v_pk_mul_f32 v[134:135], v[134:135], v[16:17]
    v_cvt_pk_bf16_f32 v83, v134, v135
    v_alignbit_b32 v42, v199, v198, 16
    v_max_f32 v16, 0, v136
    v_max_f32 v17, 0, v137
    v_pk_mul_f32 v[136:137], v[136:137], v[16:17]
    v_cvt_pk_bf16_f32 v84, v136, v137
    v_alignbit_b32 v43, v200, v199, 16
    v_max_f32 v16, 0, v138
    v_max_f32 v17, 0, v139
    v_pk_mul_f32 v[138:139], v[138:139], v[16:17]
    v_cvt_pk_bf16_f32 v85, v138, v139
    ds_write_b128 v35, v[40:43] offset:4160
    v_max_f32 v16, 0, v140
    v_max_f32 v17, 0, v141
    v_pk_mul_f32 v[140:141], v[140:141], v[16:17]
    v_cvt_pk_bf16_f32 v86, v140, v141
    v_mov_b32 v44, v197
    v_max_f32 v16, 0, v142
    v_max_f32 v17, 0, v143
    v_pk_mul_f32 v[142:143], v[142:143], v[16:17]
    v_cvt_pk_bf16_f32 v87, v142, v143
    v_mov_b32 v45, v198
    buffer_store_dwordx4 v[80:83], v12, s[44:47], 0 offen offset:0 sc1
    buffer_store_dwordx4 v[84:87], v12, s[44:47], 0 offen offset:1024 sc1
    v_max_f32 v16, 0, v144
    v_max_f32 v17, 0, v145
    v_pk_mul_f32 v[144:145], v[144:145], v[16:17]
    v_cvt_pk_bf16_f32 v88, v144, v145
    v_mov_b32 v46, v199
    v_max_f32 v16, 0, v146
    v_max_f32 v17, 0, v147
    v_pk_mul_f32 v[146:147], v[146:147], v[16:17]
    v_cvt_pk_bf16_f32 v89, v146, v147
    v_mov_b32 v47, v200
    v_max_f32 v16, 0, v148
    v_max_f32 v17, 0, v149
    v_pk_mul_f32 v[148:149], v[148:149], v[16:17]
    v_cvt_pk_bf16_f32 v90, v148, v149
    ds_write_b128 v35, v[44:47] offset:8320
    v_max_f32 v16, 0, v150
    v_max_f32 v17, 0, v151
    v_pk_mul_f32 v[150:151], v[150:151], v[16:17]
    v_cvt_pk_bf16_f32 v91, v150, v151
    v_alignbit_b32 v48, v198, v197, 16
    v_max_f32 v16, 0, v152
    v_max_f32 v17, 0, v153
    v_pk_mul_f32 v[152:153], v[152:153], v[16:17]
    v_cvt_pk_bf16_f32 v92, v152, v153
    v_alignbit_b32 v49, v199, v198, 16
    v_max_f32 v16, 0, v154
    v_max_f32 v17, 0, v155
    v_pk_mul_f32 v[154:155], v[154:155], v[16:17]
    v_cvt_pk_bf16_f32 v93, v154, v155
    v_alignbit_b32 v50, v200, v199, 16
    v_max_f32 v16, 0, v156
    v_max_f32 v17, 0, v157
    v_pk_mul_f32 v[156:157], v[156:157], v[16:17]
    v_cvt_pk_bf16_f32 v94, v156, v157
    v_alignbit_b32 v51, v201, v200, 16
    v_max_f32 v16, 0, v158
    v_max_f32 v17, 0, v159
    v_pk_mul_f32 v[158:159], v[158:159], v[16:17]
    v_cvt_pk_bf16_f32 v95, v158, v159
    ds_write_b128 v35, v[48:51] offset:12480
    buffer_store_dwordx4 v[88:91], v13, s[44:47], 0 offen offset:0 sc1
    buffer_store_dwordx4 v[92:95], v13, s[44:47], 0 offen offset:1024 sc1
    v_max_f32 v16, 0, v160
    v_max_f32 v17, 0, v161
    v_pk_mul_f32 v[160:161], v[160:161], v[16:17]
    v_cvt_pk_bf16_f32 v80, v160, v161
    ds_write_b128 v35, v[204:207] offset:2048
    v_max_f32 v16, 0, v162
    v_max_f32 v17, 0, v163
    v_pk_mul_f32 v[162:163], v[162:163], v[16:17]
    v_cvt_pk_bf16_f32 v81, v162, v163
    v_alignbit_b32 v40, v205, v204, 16
    v_max_f32 v16, 0, v164
    v_max_f32 v17, 0, v165
    v_pk_mul_f32 v[164:165], v[164:165], v[16:17]
    v_cvt_pk_bf16_f32 v82, v164, v165
    v_alignbit_b32 v41, v206, v205, 16
    v_max_f32 v16, 0, v166
    v_max_f32 v17, 0, v167
    v_pk_mul_f32 v[166:167], v[166:167], v[16:17]
    v_cvt_pk_bf16_f32 v83, v166, v167
    v_alignbit_b32 v42, v207, v206, 16
    v_max_f32 v16, 0, v168
    v_max_f32 v17, 0, v169
    v_pk_mul_f32 v[168:169], v[168:169], v[16:17]
    v_cvt_pk_bf16_f32 v84, v168, v169
    v_alignbit_b32 v43, v208, v207, 16
    v_max_f32 v16, 0, v170
    v_max_f32 v17, 0, v171
    v_pk_mul_f32 v[170:171], v[170:171], v[16:17]
    v_cvt_pk_bf16_f32 v85, v170, v171
    ds_write_b128 v35, v[40:43] offset:6208
    v_max_f32 v16, 0, v172
    v_max_f32 v17, 0, v173
    v_pk_mul_f32 v[172:173], v[172:173], v[16:17]
    v_cvt_pk_bf16_f32 v86, v172, v173
    v_mov_b32 v44, v205
    v_max_f32 v16, 0, v174
    v_max_f32 v17, 0, v175
    v_pk_mul_f32 v[174:175], v[174:175], v[16:17]
    v_cvt_pk_bf16_f32 v87, v174, v175
    v_mov_b32 v45, v206
    buffer_store_dwordx4 v[80:83], v12, s[44:47], 0 offen offset:2048 sc1
    buffer_store_dwordx4 v[84:87], v12, s[44:47], 0 offen offset:3072 sc1
    v_max_f32 v16, 0, v176
    v_max_f32 v17, 0, v177
    v_pk_mul_f32 v[176:177], v[176:177], v[16:17]
    v_cvt_pk_bf16_f32 v88, v176, v177
    v_mov_b32 v46, v207
    v_max_f32 v16, 0, v178
    v_max_f32 v17, 0, v179
    v_pk_mul_f32 v[178:179], v[178:179], v[16:17]
    v_cvt_pk_bf16_f32 v89, v178, v179
    v_mov_b32 v47, v208
    v_max_f32 v16, 0, v180
    v_max_f32 v17, 0, v181
    v_pk_mul_f32 v[180:181], v[180:181], v[16:17]
    v_cvt_pk_bf16_f32 v90, v180, v181
    ds_write_b128 v35, v[44:47] offset:10368
    v_max_f32 v16, 0, v182
    v_max_f32 v17, 0, v183
    v_pk_mul_f32 v[182:183], v[182:183], v[16:17]
    v_cvt_pk_bf16_f32 v91, v182, v183
    v_alignbit_b32 v48, v206, v205, 16
    v_max_f32 v16, 0, v184
    v_max_f32 v17, 0, v185
    v_pk_mul_f32 v[184:185], v[184:185], v[16:17]
    v_cvt_pk_bf16_f32 v92, v184, v185
    v_alignbit_b32 v49, v207, v206, 16
    v_max_f32 v16, 0, v186
    v_max_f32 v17, 0, v187
    v_pk_mul_f32 v[186:187], v[186:187], v[16:17]
    v_cvt_pk_bf16_f32 v93, v186, v187
    v_alignbit_b32 v50, v208, v207, 16
    v_max_f32 v16, 0, v188
    v_max_f32 v17, 0, v189
    v_pk_mul_f32 v[188:189], v[188:189], v[16:17]
    v_cvt_pk_bf16_f32 v94, v188, v189
    v_alignbit_b32 v51, v209, v208, 16
    v_max_f32 v16, 0, v190
    v_max_f32 v17, 0, v191
    v_pk_mul_f32 v[190:191], v[190:191], v[16:17]
    v_cvt_pk_bf16_f32 v95, v190, v191
    ds_write_b128 v35, v[48:51] offset:14528
    buffer_store_dwordx4 v[88:91], v13, s[44:47], 0 offen offset:2048 sc1
    buffer_store_dwordx4 v[92:95], v13, s[44:47], 0 offen offset:3072 sc1
    v_and_b32 v4, 127, v0
    v_cmp_gt_u32 vcc, 2, v4
    s_nop 0
    s_and_saveexec_b64 s[62:63], vcc
    s_cbranch_execz L_skip3_8
    ds_write_b128 v35, v[212:215] offset:4096
    v_alignbit_b32 v40, v213, v212, 16
    v_alignbit_b32 v41, v214, v213, 16
    v_alignbit_b32 v42, v215, v214, 16
    v_alignbit_b32 v43, v216, v215, 16
    ds_write_b128 v35, v[40:43] offset:8256
    v_mov_b32 v44, v213
    v_mov_b32 v45, v214
    v_mov_b32 v46, v215
    v_mov_b32 v47, v216
    ds_write_b128 v35, v[44:47] offset:12416
    v_alignbit_b32 v48, v214, v213, 16
    v_alignbit_b32 v49, v215, v214, 16
    v_alignbit_b32 v50, v216, v215, 16
    v_alignbit_b32 v51, v217, v216, 16
    ds_write_b128 v35, v[48:51] offset:16576
L_skip3_8:
    s_mov_b64 exec, s[62:63]
    s_branch L_conv
L_stats:
    s_sub_u32 s64, s2, 224
    s_mov_b32 s52, s18
    s_mov_b32 s53, s19
    s_mov_b32 s54, 1835008
    s_mov_b32 s55, 0x00020000
    s_min_u32 s65, s64, 27
    v_lshrrev_b32 v9, 3, v1
    v_and_b32 v11, 7, v1
    v_mul_u32_u24 v9, 3584, v9
    v_lshl_add_u32 v9, v11, 4, v9
    s_mul_i32 s62, s32, 458752
    s_lshl_b32 s63, s65, 7
    s_add_u32 s62, s62, s63
    v_add_u32 v45, s62, v9
    buffer_load_dwordx4 v[128:131], v45, s[52:55], 0 offen
    v_add_u32 v45, 28672, v45
    buffer_load_dwordx4 v[132:135], v45, s[52:55], 0 offen
    v_add_u32 v45, 28672, v45
    buffer_load_dwordx4 v[136:139], v45, s[52:55], 0 offen
    v_add_u32 v45, 28672, v45
    buffer_load_dwordx4 v[140:143], v45, s[52:55], 0 offen
    v_add_u32 v45, 28672, v45
    buffer_load_dwordx4 v[144:147], v45, s[52:55], 0 offen
    v_add_u32 v45, 28672, v45
    buffer_load_dwordx4 v[148:151], v45, s[52:55], 0 offen
    v_add_u32 v45, 28672, v45
    buffer_load_dwordx4 v[152:155], v45, s[52:55], 0 offen
    v_add_u32 v45, 28672, v45
    buffer_load_dwordx4 v[156:159], v45, s[52:55], 0 offen
    v_add_u32 v45, 28672, v45
    s_lshl_b32 s62, s2, 6
    s_and_b32 s63, s2, 7
    s_lshl_b32 s63, s63, 6
    s_lshr_b32 s44, s2, 3
    s_lshl_b32 s44, s44, 1
    s_add_u32 s63, s63, s44
    s_lshl_b32 s63, s63, 5
    s_cmp_lt_u32 s32, 2
    s_cselect_b32 s62, s62, s63
    s_and_b32 s63, s32, 1
    s_lshl_b32 s63, s63, 5
    s_add_u32 s62, s62, s63
    v_and_b32 v18, 31, v1
    v_add_u32 v18, s62, v18
    s_cmp_lt_u32 s32, 2
    s_cselect_b32 s44, s22, s12
    s_cselect_b32 s45, s23, s13
    s_mov_b32 s46, 2097152
    s_cselect_b32 s46, 1835008, s46
    s_mov_b32 s47, 0x00020000
    s_lshr_b32 s63, s46, 7
    s_sub_u32 s63, s63, 1
    v_min_u32 v18, s63, v18
    v_lshlrev_b32 v18, 7, v18
    buffer_load_dword v19, v18, s[44:47], 0 offen
    s_lshr_b32 s71, s32, 1
    s_and_b32 s72, s32, 1
    s_and_b32 s60, s2, 7
    s_lshl_b32 s73, s60, 6
    s_lshr_b32 s60, s2, 3
    s_lshl_b32 s60, s60, 1
    s_add_u32 s73, s73, s60
    s_add_u32 s73, s73, s71
    s_lshl_b32 s74, s73, 12
    s_mul_i32 s62, s71, 4608
    s_add_u32 s62, s62, 33792
    s_mul_i32 s63, s71, 16640
    s_sub_u32 s60, s62, 512
    v_and_b32 v4, 31, v1
    v_lshlrev_b32 v4, 4, v4
    v_add_u32 v4, s60, v4
    v_accvgpr_write_b32 a112, v4
    s_lshl_b32 s60, s72, 11
    s_add_u32 s60, s60, s62
    v_lshlrev_b32 v4, 4, v1
    v_add_u32 v4, s60, v4
    v_accvgpr_write_b32 a113, v4
    v_and_b32 v4, 15, v1
    v_add_u32 v4, 1, v4
    v_lshrrev_b32 v5, 4, v1
    v_and_b32 v6, 3, v4
    v_mul_u32_u24 v6, 4160, v6
    v_and_b32 v7, 0x1c, v4
    v_lshl_add_u32 v7, v5, 3, v7
    v_lshl_add_u32 v6, v7, 1, v6
    s_lshl_b32 s60, s72, 8
    s_add_u32 s60, s60, s63
    v_add_u32 v6, s60, v6
    v_accvgpr_write_b32 a114, v6
    v_and_b32 v4, 15, v1
    v_lshlrev_b32 v4, 5, v4
    v_lshlrev_b32 v5, 4, v5
    v_sub_u32 v4, v4, v5
    s_lshl_b32 s60, s72, 8
    s_sub_u32 s60, s62, s60
    s_add_u32 s60, s60, 16
    s_sub_u32 s60, s60, 256
    v_add_u32 v4, s60, v4
    v_accvgpr_write_b32 a115, v4
    v_lshrrev_b32 v5, 5, v1
    v_and_b32 v6, 15, v1
    v_lshrrev_b32 v7, 2, v6
    v_lshl_add_u32 v8, v5, 2, v7
    v_lshlrev_b32 v8, 7, v8
    v_bfe_u32 v9, v1, 4, 1
    v_bfe_u32 v10, v1, 1, 1
    v_lshl_add_u32 v9, v9, 1, v10
    v_lshl_add_u32 v8, v9, 4, v8
    v_and_b32 v9, 1, v1
    v_lshl_add_u32 v8, v9, 3, v8
    s_lshl_b32 s60, s32, 11
    s_add_u32 s60, s60, 42496
    v_bfe_u32 v9, v1, 3, 1
    v_add_u32 v8, s60, v8
    v_xor_b32 v10, 0, v9
    v_lshl_add_u32 v10, v10, 6, v8
    v_accvgpr_write_b32 a116, v10
    v_xor_b32 v10, 1, v9
    v_lshl_add_u32 v10, v10, 6, v8
    v_accvgpr_write_b32 a117, v10
    s_and_b32 s60, s2, 7
    s_lshl_b32 s62, s60, 2
    s_lshr_b32 s61, s2, 3
    s_and_b32 s60, s61, 3
    s_add_u32 s62, s62, s60
    s_lshr_b32 s63, s61, 2
    v_lshrrev_b32 v8, 2, v1
    v_and_b32 v9, 3, v1
    v_bfe_u32 v10, v1, 4, 2
    v_xor_b32 v9, v9, v10
    v_lshlrev_b32 v9, 4, v9
    v_lshl_add_u32 v9, v8, 10, v9
    s_lshl_b32 s60, s62, 16
    s_and_b32 s61, s32, 1
    s_lshl_b32 s61, s61, 15
    s_add_u32 s60, s60, s61
    s_lshl_b32 s61, s63, 7
    s_add_u32 s60, s60, s61
    s_lshr_b32 s61, s32, 1
    s_lshl_b32 s61, s61, 6
    s_add_u32 s60, s60, s61
    v_add_u32 v9, s60, v9
    v_accvgpr_write_b32 a118, v9
    s_lshr_b32 s60, s62, 1
    s_lshl_b32 s60, s60, 4
    s_add_u32 s60, s60, 512
    s_lshl_b32 s60, s60, 7
    v_cmp_gt_u32 vcc, 14, v1
    s_nop 1
    v_cndmask_b32 v9, 0, v1, vcc
    v_lshlrev_b32 v9, 7, v9
    v_add_u32 v9, s60, v9
    v_accvgpr_write_b32 a119, v9
    s_lshl_b32 s60, s62, 1
    s_mul_i32 s60, s60, 112
    s_mul_i32 s61, s32, 28
    s_add_u32 s60, s60, s61
    s_lshl_b32 s60, s60, 10
    v_lshlrev_b32 v9, 4, v1
    v_add_u32 v9, s60, v9
    v_accvgpr_write_b32 a120, v9
    s_lshl_b32 s60, s62, 6
    s_and_b32 s61, s32, 1
    s_lshl_b32 s61, s61, 5
    s_add_u32 s60, s60, s61
    v_and_b32 v9, 31, v1
    v_add_u32 v9, s60, v9
    v_lshlrev_b32 v9, 3, v9
    v_accvgpr_write_b32 a121, v9
    v_and_b32 v8, 31, v1
    v_bfe_u32 v9, v1, 2, 2
    s_lshl_b32 s60, s32, 11
    s_add_u32 s60, s60, 24576
    v_lshlrev_b32 v8, 6, v8
    v_lshl_add_u32 v8, v5, 3, v8
    v_add_u32 v8, s60, v8
    v_xor_b32 v10, 0, v9
    v_lshl_add_u32 v10, v10, 4, v8
    v_accvgpr_write_b32 a122, v10
    v_xor_b32 v10, 1, v9
    v_lshl_add_u32 v10, v10, 4, v8
    v_accvgpr_write_b32 a123, v10
    v_xor_b32 v10, 2, v9
    v_lshl_add_u32 v10, v10, 4, v8
    v_accvgpr_write_b32 a124, v10
    v_xor_b32 v10, 3, v9
    v_lshl_add_u32 v10, v10, 4, v8
    v_accvgpr_write_b32 a125, v10
    s_waitcnt vmcnt(9)
    s_barrier
    v_mov_b32 v54, 0
    global_load_dword v55, v54, s[28:29] sc1
    v_and_b32 v12, 7, v1
    v_mul_u32_u24 v14, 1040, v12
    v_lshl_add_u32 v14, v13, 2, v14
    v_add_u32 v14, 131072, v14
    ds_read_b32 v20, v14 offset:640
    ds_read_b32 v21, v14 offset:768
    ds_read_b32 v22, v14 offset:896
    ds_read_b32 v23, v14 offset:1040
    ds_read_b32 v24, v14 offset:1168
    ds_read_b32 v25, v14 offset:1296
    ds_read_b32 v26, v14 offset:1424
    ds_read_b32 v27, v14 offset:1552
    ds_read_b32 v28, v14 offset:1680
    ds_read_b32 v29, v14 offset:1808
    ds_read_b32 v30, v14 offset:1936
    ds_read_b32 v32, v14 offset:9360
    ds_read_b32 v33, v14 offset:9488
    ds_read_b32 v34, v14 offset:9616
    ds_read_b32 v35, v14 offset:9744
    ds_read_b32 v36, v14 offset:9872
    ds_read_b32 v37, v14 offset:10000
    ds_read_b32 v38, v14 offset:10128
    ds_read_b32 v39, v14 offset:10256
    v_lshlrev_b32 v56, 16, v40
    v_and_b32 v57, 0xffff0000, v40
    v_lshlrev_b32 v58, 16, v41
    v_and_b32 v59, 0xffff0000, v41
    v_lshlrev_b32 v60, 16, v42
    v_and_b32 v61, 0xffff0000, v42
    v_lshlrev_b32 v62, 16, v43
    v_and_b32 v63, 0xffff0000, v43
    s_waitcnt lgkmcnt(8)
    v_lshlrev_b32 v196, 16, v20
    v_and_b32 v207, 0xffff0000, v20
    v_lshlrev_b32 v197, 16, v21
    v_and_b32 v208, 0xffff0000, v21
    v_lshlrev_b32 v198, 16, v22
    v_and_b32 v209, 0xffff0000, v22
    buffer_load_dwordx4 v[160:163], v45, s[52:55], 0 offen
    v_add_u32 v45, 28672, v45
    v_lshlrev_b32 v199, 16, v23
    v_and_b32 v210, 0xffff0000, v23
    v_lshlrev_b32 v200, 16, v24
    v_and_b32 v211, 0xffff0000, v24
    v_lshlrev_b32 v201, 16, v25
    v_and_b32 v212, 0xffff0000, v25
    v_lshlrev_b32 v202, 16, v26
    v_and_b32 v213, 0xffff0000, v26
    v_lshlrev_b32 v203, 16, v27
    v_and_b32 v214, 0xffff0000, v27
    v_lshlrev_b32 v204, 16, v28
    v_and_b32 v215, 0xffff0000, v28
    v_lshlrev_b32 v205, 16, v29
    v_and_b32 v216, 0xffff0000, v29
    v_lshlrev_b32 v206, 16, v30
    buffer_load_dwordx4 v[164:167], v45, s[52:55], 0 offen
    v_add_u32 v45, 28672, v45
    v_and_b32 v217, 0xffff0000, v30
    v_mul_f32 v220, v199, v56
    v_fmac_f32 v220, v198, v57
    v_fmac_f32 v220, v197, v58
    v_fmac_f32 v220, v196, v59
    v_mul_f32 v221, v200, v56
    v_fmac_f32 v221, v199, v57
    v_fmac_f32 v221, v198, v58
    v_fmac_f32 v221, v197, v59
    v_mul_f32 v222, v201, v56
    v_fmac_f32 v222, v200, v57
    v_fmac_f32 v222, v199, v58
    v_fmac_f32 v222, v198, v59
    v_mul_f32 v223, v202, v56
    v_fmac_f32 v223, v201, v57
    buffer_load_dwordx4 v[168:171], v45, s[52:55], 0 offen
    v_add_u32 v45, 28672, v45
    v_fmac_f32 v223, v200, v58
    v_fmac_f32 v223, v199, v59
    v_mul_f32 v224, v203, v56
    v_fmac_f32 v224, v202, v57
    v_fmac_f32 v224, v201, v58
    v_fmac_f32 v224, v200, v59
    v_mul_f32 v225, v204, v56
    v_fmac_f32 v225, v203, v57
    v_fmac_f32 v225, v202, v58
    v_fmac_f32 v225, v201, v59
    v_mul_f32 v226, v205, v56
    v_fmac_f32 v226, v204, v57
    v_fmac_f32 v226, v203, v58
    v_fmac_f32 v226, v202, v59
    v_mul_f32 v227, v206, v56
    buffer_load_dwordx4 v[172:175], v45, s[52:55], 0 offen
    v_add_u32 v45, 28672, v45
    v_fmac_f32 v227, v205, v57
    v_fmac_f32 v227, v204, v58
    v_fmac_f32 v227, v203, v59
    v_mul_f32 v228, v210, v60
    v_fmac_f32 v228, v209, v61
    v_fmac_f32 v228, v208, v62
    v_fmac_f32 v228, v207, v63
    v_mul_f32 v229, v211, v60
    v_fmac_f32 v229, v210, v61
    v_fmac_f32 v229, v209, v62
    v_fmac_f32 v229, v208, v63
    v_mul_f32 v230, v212, v60
    v_fmac_f32 v230, v211, v61
    v_fmac_f32 v230, v210, v62
    v_fmac_f32 v230, v209, v63
    buffer_load_dwordx4 v[176:179], v45, s[52:55], 0 offen
    v_add_u32 v45, 28672, v45
    v_mul_f32 v231, v213, v60
    v_fmac_f32 v231, v212, v61
    v_fmac_f32 v231, v211, v62
    v_fmac_f32 v231, v210, v63
    v_mul_f32 v232, v214, v60
    v_fmac_f32 v232, v213, v61
    v_fmac_f32 v232, v212, v62
    v_fmac_f32 v232, v211, v63
    v_mul_f32 v233, v215, v60
    v_fmac_f32 v233, v214, v61
    v_fmac_f32 v233, v213, v62
    v_fmac_f32 v233, v212, v63
    v_mul_f32 v234, v216, v60
    v_fmac_f32 v234, v215, v61
    v_fmac_f32 v234, v214, v62
    buffer_load_dwordx4 v[180:183], v45, s[52:55], 0 offen
    v_add_u32 v45, 28672, v45
    v_fmac_f32 v234, v213, v63
    v_mul_f32 v235, v217, v60
    v_fmac_f32 v235, v216, v61
    v_fmac_f32 v235, v215, v62
    v_fmac_f32 v235, v214, v63
    s_waitcnt lgkmcnt(0)
    v_lshlrev_b32 v5, 16, v32
    v_and_b32 v6, 0xffff0000, v32
    v_mul_f32 v220, v220, v5
    v_mul_f32 v228, v228, v6
    v_lshlrev_b32 v5, 16, v33
    v_and_b32 v6, 0xffff0000, v33
    v_mul_f32 v221, v221, v5
    v_mul_f32 v229, v229, v6
    v_lshlrev_b32 v5, 16, v34
    buffer_load_dwordx4 v[184:187], v45, s[52:55], 0 offen
    v_add_u32 v45, 28672, v45
    v_and_b32 v6, 0xffff0000, v34
    v_mul_f32 v222, v222, v5
    v_mul_f32 v230, v230, v6
    v_lshlrev_b32 v5, 16, v35
    v_and_b32 v6, 0xffff0000, v35
    v_mul_f32 v223, v223, v5
    v_mul_f32 v231, v231, v6
    v_lshlrev_b32 v5, 16, v36
    v_and_b32 v6, 0xffff0000, v36
    v_mul_f32 v224, v224, v5
    v_mul_f32 v232, v232, v6
    v_lshlrev_b32 v5, 16, v37
    v_and_b32 v6, 0xffff0000, v37
    v_mul_f32 v225, v225, v5
    v_mul_f32 v233, v233, v6
    buffer_load_dwordx4 v[188:191], v45, s[52:55], 0 offen
    v_lshlrev_b32 v5, 16, v38
    v_and_b32 v6, 0xffff0000, v38
    v_mul_f32 v226, v226, v5
    v_mul_f32 v234, v234, v6
    v_lshlrev_b32 v5, 16, v39
    v_and_b32 v6, 0xffff0000, v39
    v_mul_f32 v227, v227, v5
    v_mul_f32 v235, v235, v6
    v_cvt_pk_bf16_f32 v236, v227, v226
    v_cvt_pk_bf16_f32 v237, v225, v224
    v_cvt_pk_bf16_f32 v238, v223, v222
    v_cvt_pk_bf16_f32 v239, v221, v220
    v_cvt_pk_bf16_f32 v240, v235, v234
    v_cvt_pk_bf16_f32 v241, v233, v232
    v_cvt_pk_bf16_f32 v242, v231, v230
    v_cvt_pk_bf16_f32 v243, v229, v228
    s_mov_b32 s36, s30
    s_mov_b32 s37, s31
    s_mov_b32 s38, 2097152
    s_mov_b32 s39, 0x00020000
    s_lshr_b32 s60, s2, 3
    s_and_b32 s61, s2, 7
    s_lshl_b32 s62, s61, 18
    s_lshl_b32 s63, s60, 7
    s_add_u32 s62, s62, s63
    v_lshlrev_b32 v17, 13, v13
    v_lshl_add_u32 v17, v12, 4, v17
    v_add_u32 v17, s62, v17
    buffer_store_dwordx4 v[236:239], v17, s[36:39], 0 offen sc1
    s_nop 1
    v_add_u32 v17, 4096, v17
    buffer_store_dwordx4 v[240:243], v17, s[36:39], 0 offen sc1
    s_mov_b32 s62, 0x3f803f80
    v_mov_b32 v4, 0
    v_mov_b32 v5, 0
    v_dot2_f32_bf16 v4, v100, s62, v4
    v_dot2_f32_bf16 v5, v100, v100, v5
    v_dot2_f32_bf16 v4, v101, s62, v4
    v_dot2_f32_bf16 v5, v101, v101, v5
    v_dot2_f32_bf16 v4, v102, s62, v4
    v_dot2_f32_bf16 v5, v102, v102, v5
    v_dot2_f32_bf16 v4, v103, s62, v4
    v_dot2_f32_bf16 v5, v103, v103, v5
    v_dot2_f32_bf16 v4, v104, s62, v4
    v_dot2_f32_bf16 v5, v104, v104, v5
    v_dot2_f32_bf16 v4, v105, s62, v4
    v_dot2_f32_bf16 v5, v105, v105, v5
    v_dot2_f32_bf16 v4, v106, s62, v4
    v_dot2_f32_bf16 v5, v106, v106, v5
    v_dot2_f32_bf16 v4, v107, s62, v4
    v_dot2_f32_bf16 v5, v107, v107, v5
    s_nop 1
    v_add_f32_dpp v6, v4, v4 quad_perm:[1,0,3,2] row_mask:0xf bank_mask:0xf
    s_nop 1
    v_add_f32_dpp v4, v6, v6 quad_perm:[2,3,0,1] row_mask:0xf bank_mask:0xf
    s_nop 1
    v_add_f32_dpp v6, v4, v4 row_half_mirror row_mask:0xf bank_mask:0xf
    s_nop 1
    v_add_f32_dpp v4, v6, v6 row_mirror row_mask:0xf bank_mask:0xf
    v_mov_b32 v6, v4
    s_nop 1
    v_permlane16_swap_b32 v4, v6
    v_add_f32 v4, v4, v6
    s_nop 0
    v_add_f32_dpp v6, v5, v5 quad_perm:[1,0,3,2] row_mask:0xf bank_mask:0xf
    s_nop 1
    v_add_f32_dpp v5, v6, v6 quad_perm:[2,3,0,1] row_mask:0xf bank_mask:0xf
    s_nop 1
    v_add_f32_dpp v6, v5, v5 row_half_mirror row_mask:0xf bank_mask:0xf
    s_nop 1
    v_add_f32_dpp v5, v6, v6 row_mirror row_mask:0xf bank_mask:0xf
    v_mov_b32 v6, v5
    s_nop 1
    v_permlane16_swap_b32 v5, v6
    v_add_f32 v5, v5, v6
    v_mul_f32 v4, 0x3b000000, v4
    v_mul_f32 v5, 0x3b000000, v5
    v_fma_f32 v5, -v4, v4, v5
    v_max_f32 v5, 0, v5
    v_cvt_pk_bf16_f32 v5, v5, v5
    v_lshlrev_b32 v5, 16, v5
    v_add_f32 v5, 0x3727c5ac, v5
    v_cvt_pk_bf16_f32 v5, v5, v5
    v_lshlrev_b32 v5, 16, v5
    v_sqrt_f32 v5, v5
    s_nop 0
    v_cvt_pk_bf16_f32 v6, v4, v5
    s_waitcnt vmcnt(10)
    v_readfirstlane_b32 s33, v55
    s_nop 0
    s_cmp_lg_u32 s33, 0
    s_cbranch_scc1 L_nonce_ok_10
    s_mov_b32 s60, 0
L_nonce_9:
    s_sleep 1
    global_load_dword v55, v54, s[28:29] sc1
    s_add_u32 s60, s60, 1
    s_waitcnt vmcnt(0)
    v_readfirstlane_b32 s33, v55
    s_cmp_gt_u32 s60, 20000
    s_cbranch_scc1 L_nonce_ok_10
    s_cmp_eq_u32 s33, 0
    s_cbranch_scc1 L_nonce_9
L_nonce_ok_10:
    v_mov_b32 v7, s33
    s_add_u32 s44, s30, 12582912
    s_addc_u32 s45, s31, 0
    s_mov_b32 s46, 16384
    s_mov_b32 s47, 0x00020000
    s_and_b32 s62, s2, 7
    s_lshl_b32 s62, s62, 8
    s_lshr_b32 s63, s2, 3
    s_lshl_b32 s63, s63, 3
    s_add_u32 s62, s62, s63
    s_lshl_b32 s63, s32, 1
    s_add_u32 s62, s62, s63
    v_lshrrev_b32 v8, 5, v1
    v_add_u32 v8, s62, v8
    v_lshlrev_b32 v8, 3, v8
    v_and_b32 v9, 31, v1
    v_cmp_eq_u32 vcc, 0, v9
    v_mov_b32 v9, 2146435072
    s_nop 0
    v_cndmask_b32 v8, v9, v8, vcc
    buffer_store_dwordx2 v[6:7], v8, s[44:47], 0 offen sc1
    s_waitcnt vmcnt(3)
    s_mov_b32 s62, 0x00003f80
    s_mov_b32 s63, 0x3f800000
    v_mov_b32 v244, 0
    v_mov_b32 v245, 0
    v_mov_b32 v246, 0
    v_mov_b32 v247, 0
    v_mov_b32 v248, 0
    v_mov_b32 v249, 0
    v_mov_b32 v250, 0
    v_mov_b32 v251, 0
    v_dot2_f32_bf16 v244, v128, s62, v244
    v_dot2_f32_bf16 v245, v128, s63, v245
    v_dot2_f32_bf16 v246, v129, s62, v246
    v_dot2_f32_bf16 v247, v129, s63, v247
    v_dot2_f32_bf16 v248, v130, s62, v248
    v_dot2_f32_bf16 v249, v130, s63, v249
    v_dot2_f32_bf16 v250, v131, s62, v250
    v_dot2_f32_bf16 v251, v131, s63, v251
    v_dot2_f32_bf16 v244, v132, s62, v244
    v_dot2_f32_bf16 v245, v132, s63, v245
    v_dot2_f32_bf16 v246, v133, s62, v246
    v_dot2_f32_bf16 v247, v133, s63, v247
    v_dot2_f32_bf16 v248, v134, s62, v248
    v_dot2_f32_bf16 v249, v134, s63, v249
    v_dot2_f32_bf16 v250, v135, s62, v250
    v_dot2_f32_bf16 v251, v135, s63, v251
    v_dot2_f32_bf16 v244, v136, s62, v244
    v_dot2_f32_bf16 v245, v136, s63, v245
    v_dot2_f32_bf16 v246, v137, s62, v246
    v_dot2_f32_bf16 v247, v137, s63, v247
    v_dot2_f32_bf16 v248, v138, s62, v248
    v_dot2_f32_bf16 v249, v138, s63, v249
    v_dot2_f32_bf16 v250, v139, s62, v250
    v_dot2_f32_bf16 v251, v139, s63, v251
    v_dot2_f32_bf16 v244, v140, s62, v244
    v_dot2_f32_bf16 v245, v140, s63, v245
    v_dot2_f32_bf16 v246, v141, s62, v246
    v_dot2_f32_bf16 v247, v141, s63, v247
    v_dot2_f32_bf16 v248, v142, s62, v248
    v_dot2_f32_bf16 v249, v142, s63, v249
    v_dot2_f32_bf16 v250, v143, s62, v250
    v_dot2_f32_bf16 v251, v143, s63, v251
    v_dot2_f32_bf16 v244, v144, s62, v244
    v_dot2_f32_bf16 v245, v144, s63, v245
    v_dot2_f32_bf16 v246, v145, s62, v246
    v_dot2_f32_bf16 v247, v145, s63, v247
    v_dot2_f32_bf16 v248, v146, s62, v248
    v_dot2_f32_bf16 v249, v146, s63, v249
    v_dot2_f32_bf16 v250, v147, s62, v250
    v_dot2_f32_bf16 v251, v147, s63, v251
    v_dot2_f32_bf16 v244, v148, s62, v244
    v_dot2_f32_bf16 v245, v148, s63, v245
    v_dot2_f32_bf16 v246, v149, s62, v246
    v_dot2_f32_bf16 v247, v149, s63, v247
    v_dot2_f32_bf16 v248, v150, s62, v248
    v_dot2_f32_bf16 v249, v150, s63, v249
    v_dot2_f32_bf16 v250, v151, s62, v250
    v_dot2_f32_bf16 v251, v151, s63, v251
    v_dot2_f32_bf16 v244, v152, s62, v244
    v_dot2_f32_bf16 v245, v152, s63, v245
    v_dot2_f32_bf16 v246, v153, s62, v246
    v_dot2_f32_bf16 v247, v153, s63, v247
    v_dot2_f32_bf16 v248, v154, s62, v248
    v_dot2_f32_bf16 v249, v154, s63, v249
    v_dot2_f32_bf16 v250, v155, s62, v250
    v_dot2_f32_bf16 v251, v155, s63, v251
    v_dot2_f32_bf16 v244, v156, s62, v244
    v_dot2_f32_bf16 v245, v156, s63, v245
    v_dot2_f32_bf16 v246, v157, s62, v246
    v_dot2_f32_bf16 v247, v157, s63, v247
    v_dot2_f32_bf16 v248, v158, s62, v248
    v_dot2_f32_bf16 v249, v158, s63, v249
    v_dot2_f32_bf16 v250, v159, s62, v250
    v_dot2_f32_bf16 v251, v159, s63, v251
    v_dot2_f32_bf16 v244, v160, s62, v244
    v_dot2_f32_bf16 v245, v160, s63, v245
    v_dot2_f32_bf16 v246, v161, s62, v246
    v_dot2_f32_bf16 v247, v161, s63, v247
    v_dot2_f32_bf16 v248, v162, s62, v248
    v_dot2_f32_bf16 v249, v162, s63, v249
    v_dot2_f32_bf16 v250, v163, s62, v250
    v_dot2_f32_bf16 v251, v163, s63, v251
    v_dot2_f32_bf16 v244, v164, s62, v244
    v_dot2_f32_bf16 v245, v164, s63, v245
    v_dot2_f32_bf16 v246, v165, s62, v246
    v_dot2_f32_bf16 v247, v165, s63, v247
    v_dot2_f32_bf16 v248, v166, s62, v248
    v_dot2_f32_bf16 v249, v166, s63, v249
    v_dot2_f32_bf16 v250, v167, s62, v250
    v_dot2_f32_bf16 v251, v167, s63, v251
    v_dot2_f32_bf16 v244, v168, s62, v244
    v_dot2_f32_bf16 v245, v168, s63, v245
    v_dot2_f32_bf16 v246, v169, s62, v246
    v_dot2_f32_bf16 v247, v169, s63, v247
    v_dot2_f32_bf16 v248, v170, s62, v248
    v_dot2_f32_bf16 v249, v170, s63, v249
    v_dot2_f32_bf16 v250, v171, s62, v250
    v_dot2_f32_bf16 v251, v171, s63, v251
    v_dot2_f32_bf16 v244, v172, s62, v244
    v_dot2_f32_bf16 v245, v172, s63, v245
    v_dot2_f32_bf16 v246, v173, s62, v246
    v_dot2_f32_bf16 v247, v173, s63, v247
    v_dot2_f32_bf16 v248, v174, s62, v248
    v_dot2_f32_bf16 v249, v174, s63, v249
    v_dot2_f32_bf16 v250, v175, s62, v250
    v_dot2_f32_bf16 v251, v175, s63, v251
    v_dot2_f32_bf16 v244, v176, s62, v244
    v_dot2_f32_bf16 v245, v176, s63, v245
    v_dot2_f32_bf16 v246, v177, s62, v246
    v_dot2_f32_bf16 v247, v177, s63, v247
    v_dot2_f32_bf16 v248, v178, s62, v248
    v_dot2_f32_bf16 v249, v178, s63, v249
    v_dot2_f32_bf16 v250, v179, s62, v250
    v_dot2_f32_bf16 v251, v179, s63, v251
    v_dot2_f32_bf16 v244, v180, s62, v244
    v_dot2_f32_bf16 v245, v180, s63, v245
    v_dot2_f32_bf16 v246, v181, s62, v246
    v_dot2_f32_bf16 v247, v181, s63, v247
    v_dot2_f32_bf16 v248, v182, s62, v248
    v_dot2_f32_bf16 v249, v182, s63, v249
    v_dot2_f32_bf16 v250, v183, s62, v250
    v_dot2_f32_bf16 v251, v183, s63, v251
    v_dot2_f32_bf16 v244, v184, s62, v244
    v_dot2_f32_bf16 v245, v184, s63, v245
    v_dot2_f32_bf16 v246, v185, s62, v246
    v_dot2_f32_bf16 v247, v185, s63, v247
    v_dot2_f32_bf16 v248, v186, s62, v248
    v_dot2_f32_bf16 v249, v186, s63, v249
    v_dot2_f32_bf16 v250, v187, s62, v250
    v_dot2_f32_bf16 v251, v187, s63, v251
    v_dot2_f32_bf16 v244, v188, s62, v244
    v_dot2_f32_bf16 v245, v188, s63, v245
    v_dot2_f32_bf16 v246, v189, s62, v246
    v_dot2_f32_bf16 v247, v189, s63, v247
    v_dot2_f32_bf16 v248, v190, s62, v248
    v_dot2_f32_bf16 v249, v190, s63, v249
    v_dot2_f32_bf16 v250, v191, s62, v250
    v_dot2_f32_bf16 v251, v191, s63, v251
    v_add_f32_dpp v244, v244, v244 row_ror:8 row_mask:0xf bank_mask:0xf
    v_mov_b32 v6, v244
    s_nop 1
    v_permlane16_swap_b32 v244, v6
    v_add_f32 v244, v244, v6
    v_mov_b32 v6, v244
    s_nop 1
    v_permlane32_swap_b32 v244, v6
    v_add_f32 v244, v244, v6
    v_add_f32_dpp v245, v245, v245 row_ror:8 row_mask:0xf bank_mask:0xf
    v_mov_b32 v6, v245
    s_nop 1
    v_permlane16_swap_b32 v245, v6
    v_add_f32 v245, v245, v6
    v_mov_b32 v6, v245
    s_nop 1
    v_permlane32_swap_b32 v245, v6
    v_add_f32 v245, v245, v6
    v_add_f32_dpp v246, v246, v246 row_ror:8 row_mask:0xf bank_mask:0xf
    v_mov_b32 v6, v246
    s_nop 1
    v_permlane16_swap_b32 v246, v6
    v_add_f32 v246, v246, v6
    v_mov_b32 v6, v246
    s_nop 1
    v_permlane32_swap_b32 v246, v6
    v_add_f32 v246, v246, v6
    v_add_f32_dpp v247, v247, v247 row_ror:8 row_mask:0xf bank_mask:0xf
    v_mov_b32 v6, v247
    s_nop 1
    v_permlane16_swap_b32 v247, v6
    v_add_f32 v247, v247, v6
    v_mov_b32 v6, v247
    s_nop 1
    v_permlane32_swap_b32 v247, v6
    v_add_f32 v247, v247, v6
    v_add_f32_dpp v248, v248, v248 row_ror:8 row_mask:0xf bank_mask:0xf
    v_mov_b32 v6, v248
    s_nop 1
    v_permlane16_swap_b32 v248, v6
    v_add_f32 v248, v248, v6
    v_mov_b32 v6, v248
    s_nop 1
    v_permlane32_swap_b32 v248, v6
    v_add_f32 v248, v248, v6
    v_add_f32_dpp v249, v249, v249 row_ror:8 row_mask:0xf bank_mask:0xf
    v_mov_b32 v6, v249
    s_nop 1
    v_permlane16_swap_b32 v249, v6
    v_add_f32 v249, v249, v6
    v_mov_b32 v6, v249
    s_nop 1
    v_permlane32_swap_b32 v249, v6
    v_add_f32 v249, v249, v6
    v_add_f32_dpp v250, v250, v250 row_ror:8 row_mask:0xf bank_mask:0xf
    v_mov_b32 v6, v250
    s_nop 1
    v_permlane16_swap_b32 v250, v6
    v_add_f32 v250, v250, v6
    v_mov_b32 v6, v250
    s_nop 1
    v_permlane32_swap_b32 v250, v6
    v_add_f32 v250, v250, v6
    v_add_f32_dpp v251, v251, v251 row_ror:8 row_mask:0xf bank_mask:0xf
    v_mov_b32 v6, v251
    s_nop 1
    v_permlane16_swap_b32 v251, v6
    v_add_f32 v251, v251, v6
    v_mov_b32 v6, v251
    s_nop 1
    v_permlane32_swap_b32 v251, v6
    v_add_f32 v251, v251, v6
    s_lshl_b32 s62, s32, 8
    s_add_u32 s62, s62, 0
    v_and_b32 v8, 7, v1
    v_lshlrev_b32 v8, 5, v8
    v_add_u32 v8, s62, v8
    ds_write_b128 v8, v[244:247]
    ds_write_b128 v8, v[248:251] offset:16
    s_waitcnt vmcnt(0) lgkmcnt(0)
    s_barrier
    s_lshl_b32 s61, s2, 7
    s_add_u32 s61, s61, 32768
    s_cmp_lg_u32 s32, 0
    s_cbranch_scc1 L_fs_11
    v_mov_b32 v4, s61
    v_mov_b32 v5, s33
    s_mov_b64 exec, 1
    buffer_store_dword v5, v4, s[76:79], 0 offen sc1
    s_mov_b64 exec, -1
L_fs_11:
    v_lshlrev_b32 v8, 2, v1
    ds_read_b32 v96, v8 offset:0
    ds_read_b32 v97, v8 offset:256
    ds_read_b32 v98, v8 offset:512
    ds_read_b32 v99, v8 offset:768
    s_waitcnt lgkmcnt(0)
    v_add_f32 v96, v96, v97
    v_add_f32 v98, v98, v99
    v_add_f32 v96, v96, v98
    v_mov_b32 v97, s33
    s_add_u32 s44, s30, 12648448
    s_addc_u32 s45, s31, 0
    s_mov_b32 s46, 14336
    s_mov_b32 s47, 0x00020000
    s_lshl_b32 s62, s64, 9
    v_lshlrev_b32 v8, 3, v1
    v_add_u32 v8, s62, v8
    buffer_store_dwordx2 v[96:97], v8, s[44:47], 0 offen sc1
    s_lshr_b32 s71, s32, 1
    s_and_b32 s72, s32, 1
    s_and_b32 s60, s2, 7
    s_lshl_b32 s73, s60, 6
    s_lshr_b32 s60, s2, 3
    s_lshl_b32 s60, s60, 1
    s_add_u32 s73, s73, s60
    s_add_u32 s73, s73, s71
    s_lshl_b32 s74, s73, 12
    s_mov_b32 s44, s14
    s_mov_b32 s45, s15
    s_mov_b32 s46, 1024
    s_mov_b32 s47, 0x00020000
    s_lshl_b32 s60, s73, 1
    v_mov_b32 v4, s60
    buffer_load_ushort v60, v4, s[44:47], 0 offen
    s_mov_b32 s44, s24
    s_mov_b32 s45, s25
    s_mov_b32 s46, 1024
    s_mov_b32 s47, 0x00020000
    s_lshr_b32 s60, s2, 5
    s_lshl_b32 s60, s60, 7
    s_lshr_b32 s61, s32, 1
    s_lshl_b32 s61, s61, 6
    s_add_u32 s60, s60, s61
    v_lshrrev_b32 v4, 5, v1
    v_lshlrev_b32 v4, 3, v4
    v_add_u32 v4, s60, v4
    buffer_load_dwordx2 v[244:245], v4, s[44:47], 0 offen offset:0
    buffer_load_dwordx2 v[246:247], v4, s[44:47], 0 offen offset:16
    buffer_load_dwordx2 v[248:249], v4, s[44:47], 0 offen offset:32
    buffer_load_dwordx2 v[250:251], v4, s[44:47], 0 offen offset:48
    s_add_u32 s36, s12, s74
    s_addc_u32 s37, s13, 0
    s_mov_b32 s38, 4096
    s_mov_b32 s39, 0x00020000
    v_and_b32 v4, 127, v0
    v_lshlrev_b32 v5, 4, v4
    v_subrev_u32 v6, 32, v5
    v_subrev_u32 v7, 16, v5
    v_mov_b32 v8, 2146435072
    v_cmp_gt_u32 vcc, 2, v4
    s_nop 1
    v_cndmask_b32 v14, v6, v8, vcc
    v_cmp_gt_u32 vcc, 1, v4
    s_nop 1
    v_cndmask_b32 v15, v7, v8, vcc
    v_add_u32 v16, 2048, v6
    v_add_u32 v17, 2048, v7
    v_add_u32 v18, 4096, v6
    v_add_u32 v19, 4096, v7
    buffer_load_dwordx4 v[196:199], v14, s[36:39], 0 offen
    buffer_load_dwordx4 v[200:203], v15, s[36:39], 0 offen
    buffer_load_dwordx4 v[204:207], v16, s[36:39], 0 offen
    buffer_load_dwordx4 v[208:211], v17, s[36:39], 0 offen
    buffer_load_dwordx4 v[212:215], v18, s[36:39], 0 offen
    buffer_load_dwordx4 v[216:219], v19, s[36:39], 0 offen
    s_and_b32 s60, s2, 7
    s_add_u32 s60, s60, 256
    s_lshl_b32 s60, s60, 7
    v_and_b32 v61, 31, v1
    v_lshlrev_b32 v61, 10, v61
    v_add_u32 v61, s60, v61
    buffer_load_dword v62, v61, s[76:79], 0 offen sc1
    s_waitcnt vmcnt(0)
    v_cmp_ne_u32 vcc, s33, v62
    s_cbranch_vccz L_f2s_ok_12
    s_mov_b32 s60, 0
L_f2s_spin_13:
    s_sleep 4
    buffer_load_dword v62, v61, s[76:79], 0 offen sc1
    s_add_u32 s60, s60, 1
    s_waitcnt vmcnt(0)
    v_cmp_ne_u32 vcc, s33, v62
    s_cmp_gt_u32 s60, 20000
    s_cbranch_scc1 L_f2s_ok_12
    s_cbranch_vccnz L_f2s_spin_13
L_f2s_ok_12:
    s_add_u32 s36, s30, s74
    s_addc_u32 s37, s31, 0
    s_mov_b32 s38, 4096
    s_mov_b32 s39, 0x00020000
    s_lshl_b32 s60, s72, 11
    v_lshlrev_b32 v4, 4, v1
    v_add_u32 v4, s60, v4
    buffer_load_dwordx4 v[220:223], v4, s[36:39], 0 offen sc1
    buffer_load_dwordx4 v[224:227], v4, s[36:39], 0 offen offset:1024 sc1
    s_movk_i32 s75, 2000
    s_waitcnt vmcnt(0)
    s_barrier
    s_mul_i32 s68, s71, 4608
    s_add_u32 s68, s68, 33792
    s_mul_i32 s69, s71, 16640
    v_and_b32 v4, 127, v0
    v_lshlrev_b32 v5, 4, v4
    v_add_u32 v35, s69, v5
    ds_write_b128 v35, v[196:199] offset:0
    v_alignbit_b32 v40, v197, v196, 16
    v_alignbit_b32 v41, v198, v197, 16
    v_alignbit_b32 v42, v199, v198, 16
    v_alignbit_b32 v43, v200, v199, 16
    ds_write_b128 v35, v[40:43] offset:4160
    v_mov_b32 v44, v197
    v_mov_b32 v45, v198
    v_mov_b32 v46, v199
    v_mov_b32 v47, v200
    ds_write_b128 v35, v[44:47] offset:8320
    v_alignbit_b32 v48, v198, v197, 16
    v_alignbit_b32 v49, v199, v198, 16
    v_alignbit_b32 v50, v200, v199, 16
    v_alignbit_b32 v51, v201, v200, 16
    ds_write_b128 v35, v[48:51] offset:12480
    ds_write_b128 v35, v[204:207] offset:2048
    v_alignbit_b32 v40, v205, v204, 16
    v_alignbit_b32 v41, v206, v205, 16
    v_alignbit_b32 v42, v207, v206, 16
    v_alignbit_b32 v43, v208, v207, 16
    ds_write_b128 v35, v[40:43] offset:6208
    v_mov_b32 v44, v205
    v_mov_b32 v45, v206
    v_mov_b32 v46, v207
    v_mov_b32 v47, v208
    ds_write_b128 v35, v[44:47] offset:10368
    v_alignbit_b32 v48, v206, v205, 16
    v_alignbit_b32 v49, v207, v206, 16
    v_alignbit_b32 v50, v208, v207, 16
    v_alignbit_b32 v51, v209, v208, 16
    ds_write_b128 v35, v[48:51] offset:14528
    v_and_b32 v4, 127, v0
    v_cmp_gt_u32 vcc, 2, v4
    s_nop 0
    s_and_saveexec_b64 s[62:63], vcc
    s_cbranch_execz L_skip3_14
    ds_write_b128 v35, v[212:215] offset:4096
    v_alignbit_b32 v40, v213, v212, 16
    v_alignbit_b32 v41, v214, v213, 16
    v_alignbit_b32 v42, v215, v214, 16
    v_alignbit_b32 v43, v216, v215, 16
    ds_write_b128 v35, v[40:43] offset:8256
    v_mov_b32 v44, v213
    v_mov_b32 v45, v214
    v_mov_b32 v46, v215
    v_mov_b32 v47, v216
    ds_write_b128 v35, v[44:47] offset:12416
    v_alignbit_b32 v48, v214, v213, 16
    v_alignbit_b32 v49, v215, v214, 16
    v_alignbit_b32 v50, v216, v215, 16
    v_alignbit_b32 v51, v217, v216, 16
    ds_write_b128 v35, v[48:51] offset:16576
L_skip3_14:
    s_mov_b64 exec, s[62:63]
    v_lshrrev_b32 v8, 3, v1
    v_and_b32 v10, 7, v1
    v_bfe_u32 v9, v1, 4, 1
    v_lshlrev_b32 v9, 2, v9
    v_xor_b32 v11, v10, v9
    v_lshlrev_b32 v11, 4, v11
    v_lshl_add_u32 v24, v8, 10, v11
    s_lshr_b32 s60, s2, 5
    s_mul_i32 s61, s32, 458752
    s_lshl_b32 s60, s60, 7
    s_add_u32 s60, s60, s61
    v_add_u32 v24, s60, v24
    v_add_u32 v25, 8192, v24
    s_mov_b32 s48, s22
    s_mov_b32 s49, s23
    s_mov_b32 s50, 1835008
    s_mov_b32 s51, 0x00020000
    s_lshl_b32 s70, s32, 11
    s_add_u32 s70, s70, 42496
    s_mov_b32 s35, 0
    s_add_u32 m0, s70, 90112
    s_nop 0
    buffer_load_dwordx4 v24, s[48:51], s35 offen lds
    s_add_u32 m0, s70, 91136
    s_nop 0
    buffer_load_dwordx4 v25, s[48:51], s35 offen lds
    s_add_u32 s35, s35, 16384
    s_add_u32 m0, s70, 98304
    s_nop 0
    buffer_load_dwordx4 v24, s[48:51], s35 offen lds
    s_add_u32 m0, s70, 99328
    s_nop 0
    buffer_load_dwordx4 v25, s[48:51], s35 offen lds
    s_add_u32 s35, s35, 16384
    s_add_u32 m0, s70, 106496
    s_nop 0
    buffer_load_dwordx4 v24, s[48:51], s35 offen lds
    s_add_u32 m0, s70, 107520
    s_nop 0
    buffer_load_dwordx4 v25, s[48:51], s35 offen lds
    s_add_u32 s35, s35, 16384
    s_add_u32 m0, s70, 0
    s_nop 0
    buffer_load_dwordx4 v24, s[48:51], s35 offen lds
    s_add_u32 m0, s70, 1024
    s_nop 0
    buffer_load_dwordx4 v25, s[48:51], s35 offen lds
    s_add_u32 s35, s35, 16384
    s_add_u32 m0, s70, 8192
    s_nop 0
    buffer_load_dwordx4 v24, s[48:51], s35 offen lds
    s_add_u32 m0, s70, 9216
    s_nop 0
    buffer_load_dwordx4 v25, s[48:51], s35 offen lds
    s_add_u32 s35, s35, 16384
    s_waitcnt vmcnt(0)
L_conv:
    v_mov_b32 v36, 0
    v_mov_b32 v37, 0
    v_mov_b32 v38, 0
    v_mov_b32 v39, 0
    v_accvgpr_read_b32 v34, a112
    v_accvgpr_read_b32 v3, a113
    ds_write_b128 v34, v[36:39]
    v_accvgpr_read_b32 v52, a114
    v_accvgpr_read_b32 v53, a115
    v_accvgpr_read_b32 v48, a116
    v_accvgpr_read_b32 v49, a117
    s_waitcnt vmcnt(8)
    ds_write_b128 v3, v[220:223]
    ds_write_b128 v3, v[224:227] offset:1024
    s_and_b32 s60, s2, 7
    s_lshr_b32 s61, s2, 3
    s_lshl_b32 s64, s60, 2
    s_and_b32 s62, s61, 3
    s_add_u32 s64, s64, s62
    s_lshr_b32 s65, s61, 2
    s_lshr_b32 s66, s32, 1
    s_and_b32 s67, s32, 1
    v_lshrrev_b32 v3, 5, v1
    v_add_u32 v50, 0x10000, v48
    v_add_u32 v51, 0x10000, v49
    s_mov_b32 s40, s4
    s_mov_b32 s41, s5
    s_mov_b32 s42, 2097152
    s_mov_b32 s43, 0x00020000
    v_accvgpr_read_b32 v26, a118
    v_add_u32 v27, 16384, v26
    s_lshl_b32 s57, s32, 11
    v_accvgpr_read_b32 v28, a119
    s_waitcnt lgkmcnt(0)
    s_barrier
    ds_read_b64 v[96:97], v52 offset:0
    ds_read_b64 v[98:99], v52 offset:8
    ds_read_b64 v[100:101], v52 offset:512
    ds_read_b64 v[102:103], v52 offset:520
    ds_read_b64 v[104:105], v52 offset:1024
    ds_read_b64 v[106:107], v52 offset:1032
    ds_read_b64 v[108:109], v52 offset:1536
    ds_read_b64 v[110:111], v52 offset:1544
    ds_read_b64 v[112:113], v52 offset:2048
    ds_read_b64 v[114:115], v52 offset:2056
    ds_read_b64 v[116:117], v52 offset:2560
    ds_read_b64 v[118:119], v52 offset:2568
    ds_read_b64 v[120:121], v52 offset:3072
    ds_read_b64 v[122:123], v52 offset:3080
    ds_read_b64 v[124:125], v52 offset:3584
    ds_read_b64 v[126:127], v52 offset:3592
    ds_read_b128 v[128:131], v53 offset:256
    ds_read_b128 v[132:135], v53 offset:768
    ds_read_b128 v[136:139], v53 offset:1280
    ds_read_b128 v[140:143], v53 offset:1792
    ds_read_b128 v[144:147], v53 offset:2304
    ds_read_b128 v[148:151], v53 offset:2816
    ds_read_b128 v[152:155], v53 offset:3328
    ds_read_b128 v[156:159], v53 offset:3840
    s_waitcnt lgkmcnt(0)
    v_mfma_f32_16x16x32_bf16 v[64:67], v[96:99], v[128:131], 0
    ds_read_b64 v[160:161], v52 offset:64
    v_mfma_f32_16x16x32_bf16 v[68:71], v[96:99], v[132:135], 0
    ds_read_b64 v[162:163], v52 offset:72
    s_add_u32 m0, s70, 16384
    s_nop 0
    buffer_load_dwordx4 v24, s[48:51], s35 offen lds
    v_mfma_f32_16x16x32_bf16 v[72:75], v[96:99], v[136:139], 0
    ds_read_b64 v[164:165], v52 offset:576
    v_mfma_f32_16x16x32_bf16 v[76:79], v[96:99], v[140:143], 0
    ds_read_b64 v[166:167], v52 offset:584
    s_add_u32 m0, s70, 17408
    s_nop 0
    buffer_load_dwordx4 v25, s[48:51], s35 offen lds
    s_add_u32 s35, s35, 16384
    v_mfma_f32_16x16x32_bf16 v[80:83], v[96:99], v[144:147], 0
    ds_read_b64 v[168:169], v52 offset:1088
    v_mfma_f32_16x16x32_bf16 v[84:87], v[96:99], v[148:151], 0
    ds_read_b64 v[170:171], v52 offset:1096
    s_add_u32 m0, s70, 24576
    s_nop 0
    buffer_load_dwordx4 v24, s[48:51], s35 offen lds
    v_mfma_f32_16x16x32_bf16 v[88:91], v[96:99], v[152:155], 0
    ds_read_b64 v[172:173], v52 offset:1600
    v_mfma_f32_16x16x32_bf16 v[92:95], v[96:99], v[156:159], 0
    ds_read_b64 v[174:175], v52 offset:1608
    s_add_u32 m0, s70, 25600
    s_nop 0
    buffer_load_dwordx4 v25, s[48:51], s35 offen lds
    s_add_u32 s35, s35, 16384
    v_mfma_f32_16x16x32_bf16 v[68:71], v[100:103], v[128:131], v[68:71]
    ds_read_b64 v[176:177], v52 offset:2112
    v_mfma_f32_16x16x32_bf16 v[72:75], v[100:103], v[132:135], v[72:75]
    ds_read_b64 v[178:179], v52 offset:2120
    s_add_u32 m0, s70, 32768
    s_nop 0
    buffer_load_dwordx4 v24, s[48:51], s35 offen lds
    v_mfma_f32_16x16x32_bf16 v[76:79], v[100:103], v[136:139], v[76:79]
    ds_read_b64 v[180:181], v52 offset:2624
    v_mfma_f32_16x16x32_bf16 v[80:83], v[100:103], v[140:143], v[80:83]
    ds_read_b64 v[182:183], v52 offset:2632
    s_add_u32 m0, s70, 33792
    s_nop 0
    buffer_load_dwordx4 v25, s[48:51], s35 offen lds
    s_add_u32 s35, s35, 16384
    v_mfma_f32_16x16x32_bf16 v[84:87], v[100:103], v[144:147], v[84:87]
    ds_read_b64 v[184:185], v52 offset:3136
    v_mfma_f32_16x16x32_bf16 v[88:91], v[100:103], v[148:151], v[88:91]
    ds_read_b64 v[186:187], v52 offset:3144
    s_add_u32 m0, s70, 40960
    s_nop 0
    buffer_load_dwordx4 v24, s[48:51], s35 offen lds
    v_mfma_f32_16x16x32_bf16 v[92:95], v[100:103], v[152:155], v[92:95]
    ds_read_b64 v[188:189], v52 offset:3648
    v_mfma_f32_16x16x32_bf16 v[72:75], v[104:107], v[128:131], v[72:75]
    ds_read_b64 v[190:191], v52 offset:3656
    s_add_u32 m0, s70, 41984
    s_nop 0
    buffer_load_dwordx4 v25, s[48:51], s35 offen lds
    s_add_u32 s35, s35, 16384
    v_mfma_f32_16x16x32_bf16 v[76:79], v[104:107], v[132:135], v[76:79]
    ds_read_b128 v[192:195], v53 offset:192
    v_mfma_f32_16x16x32_bf16 v[80:83], v[104:107], v[136:139], v[80:83]
    ds_read_b128 v[196:199], v53 offset:704
    s_add_u32 m0, s70, 49152
    s_nop 0
    buffer_load_dwordx4 v24, s[48:51], s35 offen lds
    v_mfma_f32_16x16x32_bf16 v[84:87], v[104:107], v[140:143], v[84:87]
    ds_read_b128 v[200:203], v53 offset:1216
    v_mfma_f32_16x16x32_bf16 v[88:91], v[104:107], v[144:147], v[88:91]
    ds_read_b128 v[204:207], v53 offset:1728
    s_add_u32 m0, s70, 50176
    s_nop 0
    buffer_load_dwordx4 v25, s[48:51], s35 offen lds
    s_add_u32 s35, s35, 16384
    v_mfma_f32_16x16x32_bf16 v[92:95], v[104:107], v[148:151], v[92:95]
    ds_read_b128 v[208:211], v53 offset:2240
    v_mfma_f32_16x16x32_bf16 v[76:79], v[108:111], v[128:131], v[76:79]
    ds_read_b128 v[212:215], v53 offset:2752
    s_add_u32 m0, s70, 57344
    s_nop 0
    buffer_load_dwordx4 v24, s[48:51], s35 offen lds
    v_mfma_f32_16x16x32_bf16 v[80:83], v[108:111], v[132:135], v[80:83]
    ds_read_b128 v[216:219], v53 offset:3264
    v_mfma_f32_16x16x32_bf16 v[84:87], v[108:111], v[136:139], v[84:87]
    ds_read_b128 v[220:223], v53 offset:3776
    s_add_u32 m0, s70, 58368
    s_nop 0
    buffer_load_dwordx4 v25, s[48:51], s35 offen lds
    s_add_u32 s35, s35, 16384
    v_mfma_f32_16x16x32_bf16 v[88:91], v[108:111], v[140:143], v[88:91]
    v_mfma_f32_16x16x32_bf16 v[92:95], v[108:111], v[144:147], v[92:95]
    s_add_u32 m0, s70, 65536
    s_nop 0
    buffer_load_dwordx4 v24, s[48:51], s35 offen lds
    v_mfma_f32_16x16x32_bf16 v[80:83], v[112:115], v[128:131], v[80:83]
    v_mfma_f32_16x16x32_bf16 v[84:87], v[112:115], v[132:135], v[84:87]
    s_add_u32 m0, s70, 66560
    s_nop 0
    buffer_load_dwordx4 v25, s[48:51], s35 offen lds
    s_add_u32 s35, s35, 16384
    v_mfma_f32_16x16x32_bf16 v[88:91], v[112:115], v[136:139], v[88:91]
    v_mfma_f32_16x16x32_bf16 v[92:95], v[112:115], v[140:143], v[92:95]
    s_add_u32 m0, s70, 73728
    s_nop 0
    buffer_load_dwordx4 v24, s[48:51], s35 offen lds
    v_mfma_f32_16x16x32_bf16 v[84:87], v[116:119], v[128:131], v[84:87]
    v_mfma_f32_16x16x32_bf16 v[88:91], v[116:119], v[132:135], v[88:91]
    s_add_u32 m0, s70, 74752
    s_nop 0
    buffer_load_dwordx4 v25, s[48:51], s35 offen lds
    s_add_u32 s35, s35, 16384
    v_mfma_f32_16x16x32_bf16 v[92:95], v[116:119], v[136:139], v[92:95]
    v_mfma_f32_16x16x32_bf16 v[88:91], v[120:123], v[128:131], v[88:91]
    s_add_u32 m0, s70, 81920
    s_nop 0
    buffer_load_dwordx4 v24, s[48:51], s35 offen lds
    v_mfma_f32_16x16x32_bf16 v[92:95], v[120:123], v[132:135], v[92:95]
    v_mfma_f32_16x16x32_bf16 v[92:95], v[124:127], v[128:131], v[92:95]
    s_add_u32 m0, s70, 82944
    s_nop 0
    buffer_load_dwordx4 v25, s[48:51], s35 offen lds
    s_add_u32 s35, s35, 16384
    s_waitcnt vmcnt(28) lgkmcnt(0)
    s_waitcnt vmcnt(18)
    s_barrier
    s_lshl_b32 s61, s75, 7
    s_cmp_lg_u32 s32, 0
    s_cbranch_scc1 L_fs_15
    v_mov_b32 v8, s61
    v_mov_b32 v9, s33
    s_mov_b64 exec, 1
    buffer_store_dword v9, v8, s[76:79], 0 offen sc1
    s_mov_b64 exec, -1
L_fs_15:
    v_mfma_f32_16x16x32_bf16 v[64:67], v[160:163], v[192:195], v[64:67]
    ds_read_b64 v[96:97], v52 offset:128
    ds_read_b64 v[98:99], v52 offset:136
    v_mfma_f32_16x16x32_bf16 v[68:71], v[160:163], v[196:199], v[68:71]
    ds_read_b64 v[100:101], v52 offset:640
    ds_read_b64 v[102:103], v52 offset:648
    v_mfma_f32_16x16x32_bf16 v[72:75], v[160:163], v[200:203], v[72:75]
    ds_read_b64 v[104:105], v52 offset:1152
    ds_read_b64 v[106:107], v52 offset:1160
    v_mfma_f32_16x16x32_bf16 v[76:79], v[160:163], v[204:207], v[76:79]
    ds_read_b64 v[108:109], v52 offset:1664
    ds_read_b64 v[110:111], v52 offset:1672
    v_mfma_f32_16x16x32_bf16 v[80:83], v[160:163], v[208:211], v[80:83]
    ds_read_b64 v[112:113], v52 offset:2176
    ds_read_b64 v[114:115], v52 offset:2184
    v_mfma_f32_16x16x32_bf16 v[84:87], v[160:163], v[212:215], v[84:87]
    ds_read_b64 v[116:117], v52 offset:2688
    ds_read_b64 v[118:119], v52 offset:2696
    v_mfma_f32_16x16x32_bf16 v[88:91], v[160:163], v[216:219], v[88:91]
    ds_read_b64 v[120:121], v52 offset:3200
    ds_read_b64 v[122:123], v52 offset:3208
    v_mfma_f32_16x16x32_bf16 v[92:95], v[160:163], v[220:223], v[92:95]
    ds_read_b64 v[124:125], v52 offset:3712
    ds_read_b64 v[126:127], v52 offset:3720
    v_mfma_f32_16x16x32_bf16 v[68:71], v[164:167], v[192:195], v[68:71]
    ds_read_b128 v[128:131], v53 offset:128
    v_mfma_f32_16x16x32_bf16 v[72:75], v[164:167], v[196:199], v[72:75]
    ds_read_b128 v[132:135], v53 offset:640
    v_mfma_f32_16x16x32_bf16 v[76:79], v[164:167], v[200:203], v[76:79]
    ds_read_b128 v[136:139], v53 offset:1152
    v_mfma_f32_16x16x32_bf16 v[80:83], v[164:167], v[204:207], v[80:83]
    ds_read_b128 v[140:143], v53 offset:1664
    v_mfma_f32_16x16x32_bf16 v[84:87], v[164:167], v[208:211], v[84:87]
    ds_read_b128 v[144:147], v53 offset:2176
    v_mfma_f32_16x16x32_bf16 v[88:91], v[164:167], v[212:215], v[88:91]
    ds_read_b128 v[148:151], v53 offset:2688
    v_mfma_f32_16x16x32_bf16 v[92:95], v[164:167], v[216:219], v[92:95]
    ds_read_b128 v[152:155], v53 offset:3200
    v_mfma_f32_16x16x32_bf16 v[72:75], v[168:171], v[192:195], v[72:75]
    ds_read_b128 v[156:159], v53 offset:3712
    v_mfma_f32_16x16x32_bf16 v[76:79], v[168:171], v[196:199], v[76:79]
    ds_read_b64_tr_b16 a[0:1], v50 offset:24576
    v_mfma_f32_16x16x32_bf16 v[80:83], v[168:171], v[200:203], v[80:83]
    ds_read_b64_tr_b16 a[2:3], v50 offset:25600
    v_mfma_f32_16x16x32_bf16 v[84:87], v[168:171], v[204:207], v[84:87]
    ds_read_b64_tr_b16 a[4:5], v51 offset:24576
    v_mfma_f32_16x16x32_bf16 v[88:91], v[168:171], v[208:211], v[88:91]
    ds_read_b64_tr_b16 a[6:7], v51 offset:25600
    v_mfma_f32_16x16x32_bf16 v[92:95], v[168:171], v[212:215], v[92:95]
    ds_read_b64_tr_b16 a[8:9], v50 offset:32768
    v_mfma_f32_16x16x32_bf16 v[76:79], v[172:175], v[192:195], v[76:79]
    ds_read_b64_tr_b16 a[10:11], v50 offset:33792
    v_mfma_f32_16x16x32_bf16 v[80:83], v[172:175], v[196:199], v[80:83]
    ds_read_b64_tr_b16 a[12:13], v51 offset:32768
    v_mfma_f32_16x16x32_bf16 v[84:87], v[172:175], v[200:203], v[84:87]
    ds_read_b64_tr_b16 a[14:15], v51 offset:33792
    v_mfma_f32_16x16x32_bf16 v[88:91], v[172:175], v[204:207], v[88:91]
    ds_read_b64_tr_b16 a[16:17], v50 offset:40960
    v_mfma_f32_16x16x32_bf16 v[92:95], v[172:175], v[208:211], v[92:95]
    ds_read_b64_tr_b16 a[18:19], v50 offset:41984
    v_mfma_f32_16x16x32_bf16 v[80:83], v[176:179], v[192:195], v[80:83]
    ds_read_b64_tr_b16 a[20:21], v51 offset:40960
    v_mfma_f32_16x16x32_bf16 v[84:87], v[176:179], v[196:199], v[84:87]
    ds_read_b64_tr_b16 a[22:23], v51 offset:41984
    v_mfma_f32_16x16x32_bf16 v[88:91], v[176:179], v[200:203], v[88:91]
    ds_read_b64_tr_b16 a[24:25], v48 offset:0
    v_mfma_f32_16x16x32_bf16 v[92:95], v[176:179], v[204:207], v[92:95]
    ds_read_b64_tr_b16 a[26:27], v48 offset:1024
    v_mfma_f32_16x16x32_bf16 v[84:87], v[180:183], v[192:195], v[84:87]
    ds_read_b64_tr_b16 a[28:29], v49 offset:0
    v_mfma_f32_16x16x32_bf16 v[88:91], v[180:183], v[196:199], v[88:91]
    ds_read_b64_tr_b16 a[30:31], v49 offset:1024
    v_mfma_f32_16x16x32_bf16 v[92:95], v[180:183], v[200:203], v[92:95]
    ds_read_b64_tr_b16 a[32:33], v48 offset:8192
    v_mfma_f32_16x16x32_bf16 v[88:91], v[184:187], v[192:195], v[88:91]
    ds_read_b64_tr_b16 a[34:35], v48 offset:9216
    v_mfma_f32_16x16x32_bf16 v[92:95], v[184:187], v[196:199], v[92:95]
    v_mfma_f32_16x16x32_bf16 v[92:95], v[188:191], v[192:195], v[92:95]
    ds_read_b64_tr_b16 a[36:37], v49 offset:8192
    ds_read_b64_tr_b16 a[38:39], v49 offset:9216
    s_waitcnt vmcnt(8) lgkmcnt(0)
    v_mfma_f32_16x16x32_bf16 v[64:67], v[96:99], v[128:131], v[64:67]
    ds_read_b64 v[160:161], v52 offset:192
    ds_read_b64 v[162:163], v52 offset:200
    v_mfma_f32_16x16x32_bf16 v[68:71], v[96:99], v[132:135], v[68:71]
    ds_read_b64 v[164:165], v52 offset:704
    ds_read_b64 v[166:167], v52 offset:712
    v_mfma_f32_16x16x32_bf16 v[72:75], v[96:99], v[136:139], v[72:75]
    ds_read_b64 v[168:169], v52 offset:1216
    ds_read_b64 v[170:171], v52 offset:1224
    s_add_u32 m0, s70, 90112
    s_nop 0
    buffer_load_dwordx4 v24, s[48:51], s35 offen lds
    v_mfma_f32_16x16x32_bf16 v[76:79], v[96:99], v[140:143], v[76:79]
    ds_read_b64 v[172:173], v52 offset:1728
    ds_read_b64 v[174:175], v52 offset:1736
    v_mfma_f32_16x16x32_bf16 v[80:83], v[96:99], v[144:147], v[80:83]
    ds_read_b64 v[176:177], v52 offset:2240
    ds_read_b64 v[178:179], v52 offset:2248
    v_mfma_f32_16x16x32_bf16 v[84:87], v[96:99], v[148:151], v[84:87]
    ds_read_b64 v[180:181], v52 offset:2752
    ds_read_b64 v[182:183], v52 offset:2760
    s_add_u32 m0, s70, 91136
    s_nop 0
    buffer_load_dwordx4 v25, s[48:51], s35 offen lds
    s_add_u32 s35, s35, 16384
    v_mfma_f32_16x16x32_bf16 v[88:91], v[96:99], v[152:155], v[88:91]
    ds_read_b64 v[184:185], v52 offset:3264
    ds_read_b64 v[186:187], v52 offset:3272
    v_mfma_f32_16x16x32_bf16 v[92:95], v[96:99], v[156:159], v[92:95]
    ds_read_b64 v[188:189], v52 offset:3776
    ds_read_b64 v[190:191], v52 offset:3784
    v_mfma_f32_16x16x32_bf16 v[68:71], v[100:103], v[128:131], v[68:71]
    ds_read_b128 v[192:195], v53 offset:64
    s_add_u32 m0, s70, 98304
    s_nop 0
    buffer_load_dwordx4 v24, s[48:51], s35 offen lds
    v_mfma_f32_16x16x32_bf16 v[72:75], v[100:103], v[132:135], v[72:75]
    ds_read_b128 v[196:199], v53 offset:576
    v_mfma_f32_16x16x32_bf16 v[76:79], v[100:103], v[136:139], v[76:79]
    ds_read_b128 v[200:203], v53 offset:1088
    v_mfma_f32_16x16x32_bf16 v[80:83], v[100:103], v[140:143], v[80:83]
    ds_read_b128 v[204:207], v53 offset:1600
    s_add_u32 m0, s70, 99328
    s_nop 0
    buffer_load_dwordx4 v25, s[48:51], s35 offen lds
    s_add_u32 s35, s35, 16384
    v_mfma_f32_16x16x32_bf16 v[84:87], v[100:103], v[144:147], v[84:87]
    ds_read_b128 v[208:211], v53 offset:2112
    v_mfma_f32_16x16x32_bf16 v[88:91], v[100:103], v[148:151], v[88:91]
    ds_read_b128 v[212:215], v53 offset:2624
    v_mfma_f32_16x16x32_bf16 v[92:95], v[100:103], v[152:155], v[92:95]
    ds_read_b128 v[216:219], v53 offset:3136
    s_add_u32 m0, s70, 106496
    s_nop 0
    buffer_load_dwordx4 v24, s[48:51], s35 offen lds
    v_mfma_f32_16x16x32_bf16 v[72:75], v[104:107], v[128:131], v[72:75]
    ds_read_b128 v[220:223], v53 offset:3648
    v_mfma_f32_16x16x32_bf16 v[76:79], v[104:107], v[132:135], v[76:79]
    ds_read_b64_tr_b16 a[40:41], v48 offset:16384
    v_mfma_f32_16x16x32_bf16 v[80:83], v[104:107], v[136:139], v[80:83]
    ds_read_b64_tr_b16 a[42:43], v48 offset:17408
    s_add_u32 m0, s70, 107520
    s_nop 0
    buffer_load_dwordx4 v25, s[48:51], s35 offen lds
    s_add_u32 s35, s35, 16384
    v_mfma_f32_16x16x32_bf16 v[84:87], v[104:107], v[140:143], v[84:87]
    ds_read_b64_tr_b16 a[44:45], v49 offset:16384
    v_mfma_f32_16x16x32_bf16 v[88:91], v[104:107], v[144:147], v[88:91]
    ds_read_b64_tr_b16 a[46:47], v49 offset:17408
    v_mfma_f32_16x16x32_bf16 v[92:95], v[104:107], v[148:151], v[92:95]
    ds_read_b64_tr_b16 a[48:49], v48 offset:24576
    s_add_u32 m0, s70, 0
    s_nop 0
    buffer_load_dwordx4 v24, s[48:51], s35 offen lds
    v_mfma_f32_16x16x32_bf16 v[76:79], v[108:111], v[128:131], v[76:79]
    ds_read_b64_tr_b16 a[50:51], v48 offset:25600
    v_mfma_f32_16x16x32_bf16 v[80:83], v[108:111], v[132:135], v[80:83]
    ds_read_b64_tr_b16 a[52:53], v49 offset:24576
    v_mfma_f32_16x16x32_bf16 v[84:87], v[108:111], v[136:139], v[84:87]
    ds_read_b64_tr_b16 a[54:55], v49 offset:25600
    s_add_u32 m0, s70, 1024
    s_nop 0
    buffer_load_dwordx4 v25, s[48:51], s35 offen lds
    s_add_u32 s35, s35, 16384
    v_mfma_f32_16x16x32_bf16 v[88:91], v[108:111], v[140:143], v[88:91]
    ds_read_b64_tr_b16 a[56:57], v48 offset:32768
    v_mfma_f32_16x16x32_bf16 v[92:95], v[108:111], v[144:147], v[92:95]
    ds_read_b64_tr_b16 a[58:59], v48 offset:33792
    v_mfma_f32_16x16x32_bf16 v[80:83], v[112:115], v[128:131], v[80:83]
    ds_read_b64_tr_b16 a[60:61], v49 offset:32768
    s_add_u32 m0, s70, 8192
    s_nop 0
    buffer_load_dwordx4 v24, s[48:51], s35 offen lds
    v_mfma_f32_16x16x32_bf16 v[84:87], v[112:115], v[132:135], v[84:87]
    ds_read_b64_tr_b16 a[62:63], v49 offset:33792
    v_mfma_f32_16x16x32_bf16 v[88:91], v[112:115], v[136:139], v[88:91]
    ds_read_b64_tr_b16 a[64:65], v48 offset:40960
    v_mfma_f32_16x16x32_bf16 v[92:95], v[112:115], v[140:143], v[92:95]
    ds_read_b64_tr_b16 a[66:67], v48 offset:41984
    s_add_u32 m0, s70, 9216
    s_nop 0
    buffer_load_dwordx4 v25, s[48:51], s35 offen lds
    s_add_u32 s35, s35, 16384
    v_mfma_f32_16x16x32_bf16 v[84:87], v[116:119], v[128:131], v[84:87]
    ds_read_b64_tr_b16 a[68:69], v49 offset:40960
    v_mfma_f32_16x16x32_bf16 v[88:91], v[116:119], v[132:135], v[88:91]
    ds_read_b64_tr_b16 a[70:71], v49 offset:41984
    v_mfma_f32_16x16x32_bf16 v[92:95], v[116:119], v[136:139], v[92:95]
    ds_read_b64_tr_b16 a[72:73], v48 offset:49152
    v_mfma_f32_16x16x32_bf16 v[88:91], v[120:123], v[128:131], v[88:91]
    ds_read_b64_tr_b16 a[74:75], v48 offset:50176
    v_mfma_f32_16x16x32_bf16 v[92:95], v[120:123], v[132:135], v[92:95]
    v_mfma_f32_16x16x32_bf16 v[92:95], v[124:127], v[128:131], v[92:95]
    ds_read_b64_tr_b16 a[76:77], v49 offset:49152
    ds_read_b64_tr_b16 a[78:79], v49 offset:50176
    s_waitcnt vmcnt(10) lgkmcnt(0)
    s_barrier
    s_add_u32 m0, s57, 24576
    s_nop 0
    buffer_load_dwordx4 v26, s[40:43], 0 offen lds
    s_add_u32 m0, s57, 25600
    s_nop 0
    buffer_load_dwordx4 v27, s[40:43], 0 offen lds
    v_mfma_f32_16x16x32_bf16 v[64:67], v[160:163], v[192:195], v[64:67]
    ds_read_b64_tr_b16 a[80:81], v48 offset:57344
    v_mfma_f32_16x16x32_bf16 v[68:71], v[160:163], v[196:199], v[68:71]
    ds_read_b64_tr_b16 a[82:83], v48 offset:58368
    v_mfma_f32_16x16x32_bf16 v[72:75], v[160:163], v[200:203], v[72:75]
    ds_read_b64_tr_b16 a[84:85], v49 offset:57344
    s_add_u32 m0, s70, 16384
    s_nop 0
    buffer_load_dwordx4 v24, s[48:51], s35 offen lds
    v_mfma_f32_16x16x32_bf16 v[76:79], v[160:163], v[204:207], v[76:79]
    ds_read_b64_tr_b16 a[86:87], v49 offset:58368
    v_mfma_f32_16x16x32_bf16 v[80:83], v[160:163], v[208:211], v[80:83]
    ds_read_b64_tr_b16 a[88:89], v50 offset:0
    v_mfma_f32_16x16x32_bf16 v[84:87], v[160:163], v[212:215], v[84:87]
    ds_read_b64_tr_b16 a[90:91], v50 offset:1024
    s_add_u32 m0, s70, 17408
    s_nop 0
    buffer_load_dwordx4 v25, s[48:51], s35 offen lds
    s_add_u32 s35, s35, 16384
    v_mfma_f32_16x16x32_bf16 v[88:91], v[160:163], v[216:219], v[88:91]
    ds_read_b64_tr_b16 a[92:93], v51 offset:0
    v_mfma_f32_16x16x32_bf16 v[92:95], v[160:163], v[220:223], v[92:95]
    ds_read_b64_tr_b16 a[94:95], v51 offset:1024
    v_mfma_f32_16x16x32_bf16 v[68:71], v[164:167], v[192:195], v[68:71]
    ds_read_b64_tr_b16 a[96:97], v50 offset:8192
    s_add_u32 m0, s70, 24576
    s_nop 0
    buffer_load_dwordx4 v24, s[48:51], s35 offen lds
    v_mfma_f32_16x16x32_bf16 v[72:75], v[164:167], v[196:199], v[72:75]
    ds_read_b64_tr_b16 a[98:99], v50 offset:9216
    v_mfma_f32_16x16x32_bf16 v[76:79], v[164:167], v[200:203], v[76:79]
    ds_read_b64_tr_b16 a[100:101], v51 offset:8192
    v_mfma_f32_16x16x32_bf16 v[80:83], v[164:167], v[204:207], v[80:83]
    ds_read_b64_tr_b16 a[102:103], v51 offset:9216
    s_add_u32 m0, s70, 25600
    s_nop 0
    buffer_load_dwordx4 v25, s[48:51], s35 offen lds
    s_add_u32 s35, s35, 16384
    v_mfma_f32_16x16x32_bf16 v[84:87], v[164:167], v[208:211], v[84:87]
    ds_read_b64_tr_b16 a[104:105], v50 offset:16384
    v_mfma_f32_16x16x32_bf16 v[88:91], v[164:167], v[212:215], v[88:91]
    ds_read_b64_tr_b16 a[106:107], v50 offset:17408
    v_mfma_f32_16x16x32_bf16 v[92:95], v[164:167], v[216:219], v[92:95]
    ds_read_b64_tr_b16 a[108:109], v51 offset:16384
    s_add_u32 m0, s70, 32768
    s_nop 0
    buffer_load_dwordx4 v24, s[48:51], s35 offen lds
    v_mfma_f32_16x16x32_bf16 v[72:75], v[168:171], v[192:195], v[72:75]
    ds_read_b64_tr_b16 a[110:111], v51 offset:17408
    v_mfma_f32_16x16x32_bf16 v[76:79], v[168:171], v[196:199], v[76:79]
    v_mfma_f32_16x16x32_bf16 v[80:83], v[168:171], v[200:203], v[80:83]
    s_add_u32 m0, s70, 33792
    s_nop 0
    buffer_load_dwordx4 v25, s[48:51], s35 offen lds
    s_add_u32 s35, s35, 16384
    v_mfma_f32_16x16x32_bf16 v[84:87], v[168:171], v[204:207], v[84:87]
    v_mfma_f32_16x16x32_bf16 v[88:91], v[168:171], v[208:211], v[88:91]
    v_mfma_f32_16x16x32_bf16 v[92:95], v[168:171], v[212:215], v[92:95]
    v_mfma_f32_16x16x32_bf16 v[76:79], v[172:175], v[192:195], v[76:79]
    v_mfma_f32_16x16x32_bf16 v[80:83], v[172:175], v[196:199], v[80:83]
    v_mfma_f32_16x16x32_bf16 v[84:87], v[172:175], v[200:203], v[84:87]
    v_mfma_f32_16x16x32_bf16 v[88:91], v[172:175], v[204:207], v[88:91]
    buffer_load_dword v29, v28, s[76:79], 0 offen sc1
    v_mfma_f32_16x16x32_bf16 v[92:95], v[172:175], v[208:211], v[92:95]
    v_mfma_f32_16x16x32_bf16 v[80:83], v[176:179], v[192:195], v[80:83]
    v_mfma_f32_16x16x32_bf16 v[84:87], v[176:179], v[196:199], v[84:87]
    v_mfma_f32_16x16x32_bf16 v[88:91], v[176:179], v[200:203], v[88:91]
    v_mfma_f32_16x16x32_bf16 v[92:95], v[176:179], v[204:207], v[92:95]
    v_mfma_f32_16x16x32_bf16 v[84:87], v[180:183], v[192:195], v[84:87]
    v_mfma_f32_16x16x32_bf16 v[88:91], v[180:183], v[196:199], v[88:91]
    v_mfma_f32_16x16x32_bf16 v[92:95], v[180:183], v[200:203], v[92:95]
    v_mfma_f32_16x16x32_bf16 v[88:91], v[184:187], v[192:195], v[88:91]
    v_mfma_f32_16x16x32_bf16 v[92:95], v[184:187], v[196:199], v[92:95]
    v_mfma_f32_16x16x32_bf16 v[92:95], v[188:191], v[192:195], v[92:95]
    s_add_u32 s40, s30, 4194304
    s_addc_u32 s41, s31, 0
    s_mov_b32 s42, 7340032
    s_mov_b32 s43, 0x00020000
    v_accvgpr_read_b32 v30, a120
    v_add_u32 v31, 114688, v30
    s_mov_b32 s58, 0
    s_add_u32 s36, s30, 12582912
    s_addc_u32 s37, s31, 0
    s_mov_b32 s38, 16384
    s_mov_b32 s39, 0x00020000
    s_mov_b32 s52, s24
    s_mov_b32 s53, s25
    s_mov_b32 s54, 1024
    s_mov_b32 s55, 0x00020000
    v_accvgpr_read_b32 v54, a121
    buffer_load_dwordx2 v[16:17], v54, s[36:39], 0 offen sc1
    s_lshl_b32 s60, s65, 7
    s_lshl_b32 s61, s66, 6
    s_add_u32 s60, s60, s61
    v_lshlrev_b32 v55, 3, v3
    v_add_u32 v55, s60, v55
    s_waitcnt vmcnt(1)
    v_cmp_ne_u32 vcc, s33, v29
    s_cbranch_vccz L_f3_ok_16
    s_mov_b32 s60, 0
L_f3_spin_17:
    s_sleep 4
    buffer_load_dword v29, v28, s[76:79], 0 offen sc1
    s_add_u32 s60, s60, 1
    s_waitcnt vmcnt(0)
    v_cmp_ne_u32 vcc, s33, v29
    s_cmp_gt_u32 s60, 20000
    s_cbranch_scc1 L_f3_ok_16
    s_cbranch_vccnz L_f3_spin_17
L_f3_ok_16:
    buffer_load_dwordx4 v[128:131], v30, s[40:43], s58 offen sc1
    buffer_load_dwordx4 v[132:135], v31, s[40:43], s58 offen sc1
    s_add_u32 s58, s58, 1024
    buffer_load_dwordx4 v[136:139], v30, s[40:43], s58 offen sc1
    buffer_load_dwordx4 v[140:143], v31, s[40:43], s58 offen sc1
    s_add_u32 s58, s58, 1024
    buffer_load_dwordx4 v[144:147], v30, s[40:43], s58 offen sc1
    buffer_load_dwordx4 v[148:151], v31, s[40:43], s58 offen sc1
    s_add_u32 s58, s58, 1024
    s_lshl_b32 s60, s32, 12
    s_add_u32 s60, s60, 0
    v_lshlrev_b32 v4, 4, v1
    v_add_u32 v5, s60, v4
    s_xor_b32 s61, s32, 1
    s_lshl_b32 s61, s61, 12
    s_add_u32 s61, s61, 0
    v_add_u32 v6, s61, v4
    s_cmp_eq_u32 s72, 0
    s_cbranch_scc0 L_conv_h1
    ds_write_b128 v5, v[80:83] offset:0
    ds_write_b128 v5, v[84:87] offset:1024
    ds_write_b128 v5, v[88:91] offset:2048
    ds_write_b128 v5, v[92:95] offset:3072
    s_branch L_conv_hj
L_conv_h1:
    ds_write_b128 v5, v[64:67] offset:0
    ds_write_b128 v5, v[68:71] offset:1024
    ds_write_b128 v5, v[72:75] offset:2048
    ds_write_b128 v5, v[76:79] offset:3072
    v_mov_b32 v64, v80
    v_mov_b32 v65, v81
    v_mov_b32 v66, v82
    v_mov_b32 v67, v83
    v_mov_b32 v68, v84
    v_mov_b32 v69, v85
    v_mov_b32 v70, v86
    v_mov_b32 v71, v87
    v_mov_b32 v72, v88
    v_mov_b32 v73, v89
    v_mov_b32 v74, v90
    v_mov_b32 v75, v91
    v_mov_b32 v76, v92
    v_mov_b32 v77, v93
    v_mov_b32 v78, v94
    v_mov_b32 v79, v95
L_conv_hj:
    s_waitcnt lgkmcnt(0)
    s_barrier
    ds_read_b128 v[96:99], v6 offset:0
    ds_read_b128 v[100:103], v6 offset:1024
    ds_read_b128 v[104:107], v6 offset:2048
    ds_read_b128 v[108:111], v6 offset:3072
    v_and_b32 v7, 15, v1
    buffer_load_dwordx4 v[152:155], v30, s[40:43], s58 offen sc1
    v_lshlrev_b32 v7, 5, v7
    v_lshrrev_b32 v8, 5, v1
    v_lshl_add_u32 v7, v8, 4, v7
    v_bfe_u32 v8, v1, 4, 1
    v_lshlrev_b32 v8, 3, v8
    buffer_load_dwordx4 v[156:159], v31, s[40:43], s58 offen sc1
    s_add_u32 s58, s58, 1024
    v_sub_u32 v7, v7, v8
    s_lshl_b32 s60, s72, 11
    s_add_u32 s60, s60, s68
    s_add_u32 s60, s60, 8
    v_add_u32 v7, s60, v7
    ds_read_b64 v[112:113], v7 offset:0
    ds_read_b64 v[114:115], v7 offset:512
    ds_read_b64 v[116:117], v7 offset:1024
    buffer_load_dwordx4 v[160:163], v30, s[40:43], s58 offen sc1
    ds_read_b64 v[118:119], v7 offset:1536
    v_lshlrev_b32 v60, 16, v60
    s_waitcnt lgkmcnt(0)
    v_add_f32 v64, v64, v96
    v_add_f32 v65, v65, v97
    v_add_f32 v66, v66, v98
    buffer_load_dwordx4 v[164:167], v31, s[40:43], s58 offen sc1
    s_add_u32 s58, s58, 1024
    v_add_f32 v67, v67, v99
    v_and_b32 v9, 0xffff0000, v113
    v_fmac_f32 v64, v9, v60
    v_lshlrev_b32 v9, 16, v113
    v_fmac_f32 v65, v9, v60
    buffer_load_dwordx4 v[168:171], v30, s[40:43], s58 offen sc1
    v_and_b32 v9, 0xffff0000, v112
    v_fmac_f32 v66, v9, v60
    v_lshlrev_b32 v9, 16, v112
    v_fmac_f32 v67, v9, v60
    v_cvt_pk_bf16_f32 v120, v64, v65
    buffer_load_dwordx4 v[172:175], v31, s[40:43], s58 offen sc1
    s_add_u32 s58, s58, 1024
    v_cvt_pk_bf16_f32 v121, v66, v67
    v_add_f32 v68, v68, v100
    v_add_f32 v69, v69, v101
    v_add_f32 v70, v70, v102
    v_add_f32 v71, v71, v103
    buffer_load_dwordx4 v[176:179], v30, s[40:43], s58 offen sc1
    v_and_b32 v9, 0xffff0000, v115
    v_fmac_f32 v68, v9, v60
    v_lshlrev_b32 v9, 16, v115
    v_fmac_f32 v69, v9, v60
    v_and_b32 v9, 0xffff0000, v114
    buffer_load_dwordx4 v[180:183], v31, s[40:43], s58 offen sc1
    s_add_u32 s58, s58, 1024
    v_fmac_f32 v70, v9, v60
    v_lshlrev_b32 v9, 16, v114
    v_fmac_f32 v71, v9, v60
    v_cvt_pk_bf16_f32 v122, v68, v69
    v_cvt_pk_bf16_f32 v123, v70, v71
    buffer_load_dwordx4 v[184:187], v30, s[40:43], s58 offen sc1
    v_add_f32 v72, v72, v104
    v_add_f32 v73, v73, v105
    v_add_f32 v74, v74, v106
    v_add_f32 v75, v75, v107
    v_and_b32 v9, 0xffff0000, v117
    buffer_load_dwordx4 v[188:191], v31, s[40:43], s58 offen sc1
    s_add_u32 s58, s58, 1024
    v_fmac_f32 v72, v9, v60
    v_lshlrev_b32 v9, 16, v117
    v_fmac_f32 v73, v9, v60
    v_and_b32 v9, 0xffff0000, v116
    v_fmac_f32 v74, v9, v60
    buffer_load_dwordx4 v[192:195], v30, s[40:43], s58 offen sc1
    v_lshlrev_b32 v9, 16, v116
    v_fmac_f32 v75, v9, v60
    v_cvt_pk_bf16_f32 v124, v72, v73
    v_cvt_pk_bf16_f32 v125, v74, v75
    v_add_f32 v76, v76, v108
    buffer_load_dwordx4 v[196:199], v31, s[40:43], s58 offen sc1
    s_add_u32 s58, s58, 1024
    v_add_f32 v77, v77, v109
    v_add_f32 v78, v78, v110
    v_add_f32 v79, v79, v111
    v_and_b32 v9, 0xffff0000, v119
    v_fmac_f32 v76, v9, v60
    buffer_load_dwordx4 v[200:203], v30, s[40:43], s58 offen sc1
    v_lshlrev_b32 v9, 16, v119
    v_fmac_f32 v77, v9, v60
    v_and_b32 v9, 0xffff0000, v118
    v_fmac_f32 v78, v9, v60
    v_lshlrev_b32 v9, 16, v118
    buffer_load_dwordx4 v[204:207], v31, s[40:43], s58 offen sc1
    s_add_u32 s58, s58, 1024
    v_fmac_f32 v79, v9, v60
    v_cvt_pk_bf16_f32 v126, v76, v77
    v_cvt_pk_bf16_f32 v127, v78, v79
    s_lshl_b32 s60, s32, 11
    s_add_u32 s60, s60, 16384
    v_and_b32 v7, 15, v1
    v_lshlrev_b32 v7, 5, v7
    buffer_load_dwordx4 v[208:211], v30, s[40:43], s58 offen sc1
    v_lshrrev_b32 v8, 4, v1
    v_lshl_add_u32 v7, v8, 3, v7
    v_add_u32 v7, s60, v7
    ds_write_b64 v7, v[120:121] offset:0
    ds_write_b64 v7, v[122:123] offset:512
    buffer_load_dwordx4 v[212:215], v31, s[40:43], s58 offen sc1
    s_add_u32 s58, s58, 1024
    ds_write_b64 v7, v[124:125] offset:1024
    ds_write_b64 v7, v[126:127] offset:1536
    v_add_u32 v8, s60, v4
    s_add_u32 s52, s30, 2097152
    s_addc_u32 s53, s31, 0
    s_add_u32 s52, s52, s74
    s_addc_u32 s53, s53, 0
    s_mov_b32 s54, 4096
    s_mov_b32 s55, 0x00020000
    s_waitcnt lgkmcnt(0)
    ds_read_b128 v[96:99], v8
    ds_read_b128 v[100:103], v8 offset:1024
    buffer_load_dwordx4 v[216:219], v30, s[40:43], s58 offen sc1
    s_lshl_b32 s60, s72, 11
    v_add_u32 v9, s60, v4
    s_waitcnt lgkmcnt(1)
    buffer_store_dwordx4 v[96:99], v9, s[52:55], 0 offen sc1
    s_waitcnt lgkmcnt(0)
    buffer_store_dwordx4 v[100:103], v9, s[52:55], 0 offen offset:1024 sc1
    s_add_u32 s44, s30, 2097152
    s_addc_u32 s45, s31, 0
    s_mov_b32 s46, 2097152
    s_mov_b32 s47, 0x00020000
    s_waitcnt vmcnt(25)
    v_mov_b32 v8, v244
    v_mov_b32 v9, v245
    v_mov_b32 v10, v246
    v_mov_b32 v11, v247
    buffer_load_dwordx4 v[220:223], v31, s[40:43], s58 offen sc1
    s_add_u32 s58, s58, 1024
    v_mov_b32 v12, v248
    v_mov_b32 v13, v249
    v_mov_b32 v14, v250
    v_mov_b32 v15, v251
    v_accvgpr_read_b32 v20, a122
    buffer_load_dwordx4 v[224:227], v30, s[40:43], s58 offen sc1
    v_accvgpr_read_b32 v21, a123
    v_accvgpr_read_b32 v22, a124
    v_accvgpr_read_b32 v23, a125
    ds_read_b64 v[56:57], v20
    ds_read_b64 v[58:59], v21
    buffer_load_dwordx4 v[228:231], v31, s[40:43], s58 offen sc1
    s_add_u32 s58, s58, 1024
    ds_read_b64 v[60:61], v22
    ds_read_b64 v[62:63], v23
    v_cmp_ne_u32 vcc, s33, v17
    s_cbranch_vccz L_stat2_ok_18
    s_mov_b32 s60, 0
L_stat2_spin_19:
    s_sleep 4
    buffer_load_dwordx2 v[16:17], v54, s[36:39], 0 offen sc1
    s_add_u32 s60, s60, 1
    s_waitcnt vmcnt(0)
    v_cmp_ne_u32 vcc, s33, v17
    s_cmp_gt_u32 s60, 20000
    s_cbranch_scc1 L_stat2_ok_18
    s_cbranch_vccnz L_stat2_spin_19
L_stat2_ok_18:
    v_and_b32 v18, 0xffff0000, v16
    v_rcp_f32 v18, v18
    v_lshlrev_b32 v19, 16, v16
    buffer_load_dwordx4 v[232:235], v30, s[40:43], s58 offen sc1
    v_mul_f32 v19, v19, v18
    v_mul_f32 v17, v18, v18
    s_waitcnt lgkmcnt(0)
    buffer_load_dwordx4 v[236:239], v31, s[40:43], s58 offen sc1
    s_add_u32 s58, s58, 1024
    s_waitcnt vmcnt(28)
    v_mfma_f32_32x32x16_bf16 v[64:79], a[0:3], v[128:131], 0
    v_lshlrev_b32 v4, 16, v56
    v_lshlrev_b32 v5, 16, v8
    v_add_f32 v240, v4, v5
    v_mfma_f32_32x32x16_bf16 v[80:95], a[0:3], v[132:135], 0
    v_fma_f32 v6, v4, v18, -v19
    v_and_b32 v4, 0xffff0000, v56
    v_and_b32 v5, 0xffff0000, v8
    v_mfma_f32_32x32x16_bf16 v[96:111], a[4:7], v[128:131], 0
    v_add_f32 v241, v4, v5
    v_fma_f32 v7, v4, v18, -v19
    v_cvt_pk_bf16_f32 v8, v6, v7
    v_mfma_f32_32x32x16_bf16 v[112:127], a[4:7], v[132:135], 0
    buffer_load_dwordx4 v[128:131], v30, s[40:43], s58 offen sc1
    buffer_load_dwordx4 v[132:135], v31, s[40:43], s58 offen sc1
    s_add_u32 s58, s58, 1024
    s_waitcnt vmcnt(28)
    v_mfma_f32_32x32x16_bf16 v[64:79], a[8:11], v[136:139], v[64:79]
    v_lshlrev_b32 v4, 16, v57
    v_lshlrev_b32 v5, 16, v9
    v_add_f32 v242, v4, v5
    v_mfma_f32_32x32x16_bf16 v[80:95], a[8:11], v[140:143], v[80:95]
    v_fma_f32 v6, v4, v18, -v19
    v_and_b32 v4, 0xffff0000, v57
    v_and_b32 v5, 0xffff0000, v9
    v_mfma_f32_32x32x16_bf16 v[96:111], a[12:15], v[136:139], v[96:111]
    v_add_f32 v243, v4, v5
    v_fma_f32 v7, v4, v18, -v19
    v_cvt_pk_bf16_f32 v9, v6, v7
    v_mfma_f32_32x32x16_bf16 v[112:127], a[12:15], v[140:143], v[112:127]
    buffer_load_dwordx4 v[136:139], v30, s[40:43], s58 offen sc1
    buffer_load_dwordx4 v[140:143], v31, s[40:43], s58 offen sc1
    s_add_u32 s58, s58, 1024
    s_waitcnt vmcnt(28)
    v_mfma_f32_32x32x16_bf16 v[64:79], a[16:19], v[144:147], v[64:79]
    v_lshlrev_b32 v4, 16, v58
    v_lshlrev_b32 v5, 16, v10
    v_add_f32 v244, v4, v5
    v_mfma_f32_32x32x16_bf16 v[80:95], a[16:19], v[148:151], v[80:95]
    v_fma_f32 v6, v4, v18, -v19
    v_and_b32 v4, 0xffff0000, v58
    v_and_b32 v5, 0xffff0000, v10
    v_mfma_f32_32x32x16_bf16 v[96:111], a[20:23], v[144:147], v[96:111]
    v_add_f32 v245, v4, v5
    v_fma_f32 v7, v4, v18, -v19
    v_cvt_pk_bf16_f32 v10, v6, v7
    v_mfma_f32_32x32x16_bf16 v[112:127], a[20:23], v[148:151], v[112:127]
    buffer_load_dwordx4 v[144:147], v30, s[40:43], s58 offen sc1
    buffer_load_dwordx4 v[148:151], v31, s[40:43], s58 offen sc1
    s_add_u32 s58, s58, 1024
    s_waitcnt vmcnt(28)
    v_mfma_f32_32x32x16_bf16 v[64:79], a[24:27], v[152:155], v[64:79]
    v_lshlrev_b32 v4, 16, v59
    v_lshlrev_b32 v5, 16, v11
    v_add_f32 v246, v4, v5
    v_mfma_f32_32x32x16_bf16 v[80:95], a[24:27], v[156:159], v[80:95]
    v_fma_f32 v6, v4, v18, -v19
    v_and_b32 v4, 0xffff0000, v59
    v_and_b32 v5, 0xffff0000, v11
    v_mfma_f32_32x32x16_bf16 v[96:111], a[28:31], v[152:155], v[96:111]
    v_add_f32 v247, v4, v5
    v_fma_f32 v7, v4, v18, -v19
    v_cvt_pk_bf16_f32 v11, v6, v7
    v_mfma_f32_32x32x16_bf16 v[112:127], a[28:31], v[156:159], v[112:127]
    buffer_load_dwordx4 v[152:155], v30, s[40:43], s58 offen sc1
    buffer_load_dwordx4 v[156:159], v31, s[40:43], s58 offen sc1
    s_add_u32 s58, s58, 1024
    s_waitcnt vmcnt(28)
    v_mfma_f32_32x32x16_bf16 v[64:79], a[32:35], v[160:163], v[64:79]
    v_lshlrev_b32 v4, 16, v60
    v_lshlrev_b32 v5, 16, v12
    v_add_f32 v248, v4, v5
    v_mfma_f32_32x32x16_bf16 v[80:95], a[32:35], v[164:167], v[80:95]
    v_fma_f32 v6, v4, v18, -v19
    v_and_b32 v4, 0xffff0000, v60
    v_and_b32 v5, 0xffff0000, v12
    v_mfma_f32_32x32x16_bf16 v[96:111], a[36:39], v[160:163], v[96:111]
    v_add_f32 v249, v4, v5
    v_fma_f32 v7, v4, v18, -v19
    v_cvt_pk_bf16_f32 v12, v6, v7
    v_mfma_f32_32x32x16_bf16 v[112:127], a[36:39], v[164:167], v[112:127]
    buffer_load_dwordx4 v[160:163], v30, s[40:43], s58 offen sc1
    buffer_load_dwordx4 v[164:167], v31, s[40:43], s58 offen sc1
    s_add_u32 s58, s58, 1024
    s_waitcnt vmcnt(15)
    s_barrier
    s_lshl_b32 s61, s2, 7
    s_add_u32 s61, s61, 98304
    s_cmp_lg_u32 s32, 0
    s_cbranch_scc1 L_fs_20
    v_mov_b32 v52, s61
    v_mov_b32 v53, s33
    s_mov_b64 exec, 1
    buffer_store_dword v53, v52, s[76:79], 0 offen sc1
    s_mov_b64 exec, -1
L_fs_20:
    s_waitcnt vmcnt(28)
    v_mfma_f32_32x32x16_bf16 v[64:79], a[40:43], v[168:171], v[64:79]
    v_lshlrev_b32 v4, 16, v61
    v_lshlrev_b32 v5, 16, v13
    v_add_f32 v250, v4, v5
    v_mfma_f32_32x32x16_bf16 v[80:95], a[40:43], v[172:175], v[80:95]
    v_fma_f32 v6, v4, v18, -v19
    v_and_b32 v4, 0xffff0000, v61
    v_and_b32 v5, 0xffff0000, v13
    v_mfma_f32_32x32x16_bf16 v[96:111], a[44:47], v[168:171], v[96:111]
    v_add_f32 v251, v4, v5
    v_fma_f32 v7, v4, v18, -v19
    v_cvt_pk_bf16_f32 v13, v6, v7
    v_mfma_f32_32x32x16_bf16 v[112:127], a[44:47], v[172:175], v[112:127]
    buffer_load_dwordx4 v[168:171], v30, s[40:43], s58 offen sc1
    buffer_load_dwordx4 v[172:175], v31, s[40:43], s58 offen sc1
    s_add_u32 s58, s58, 1024
    s_waitcnt vmcnt(28)
    v_mfma_f32_32x32x16_bf16 v[64:79], a[48:51], v[176:179], v[64:79]
    v_lshlrev_b32 v4, 16, v62
    v_lshlrev_b32 v5, 16, v14
    v_add_f32 v252, v4, v5
    v_mfma_f32_32x32x16_bf16 v[80:95], a[48:51], v[180:183], v[80:95]
    v_fma_f32 v6, v4, v18, -v19
    v_and_b32 v4, 0xffff0000, v62
    v_and_b32 v5, 0xffff0000, v14
    v_mfma_f32_32x32x16_bf16 v[96:111], a[52:55], v[176:179], v[96:111]
    v_add_f32 v253, v4, v5
    v_fma_f32 v7, v4, v18, -v19
    v_cvt_pk_bf16_f32 v14, v6, v7
    v_mfma_f32_32x32x16_bf16 v[112:127], a[52:55], v[180:183], v[112:127]
    buffer_load_dwordx4 v[176:179], v30, s[40:43], s58 offen sc1
    buffer_load_dwordx4 v[180:183], v31, s[40:43], s58 offen sc1
    s_add_u32 s58, s58, 1024
    s_waitcnt vmcnt(28)
    v_mfma_f32_32x32x16_bf16 v[64:79], a[56:59], v[184:187], v[64:79]
    v_lshlrev_b32 v4, 16, v63
    v_lshlrev_b32 v5, 16, v15
    v_add_f32 v254, v4, v5
    v_mfma_f32_32x32x16_bf16 v[80:95], a[56:59], v[188:191], v[80:95]
    v_fma_f32 v6, v4, v18, -v19
    v_and_b32 v4, 0xffff0000, v63
    v_and_b32 v5, 0xffff0000, v15
    v_mfma_f32_32x32x16_bf16 v[96:111], a[60:63], v[184:187], v[96:111]
    v_add_f32 v255, v4, v5
    v_fma_f32 v7, v4, v18, -v19
    v_cvt_pk_bf16_f32 v15, v6, v7
    v_mfma_f32_32x32x16_bf16 v[112:127], a[60:63], v[188:191], v[112:127]
    buffer_load_dwordx4 v[184:187], v30, s[40:43], s58 offen sc1
    buffer_load_dwordx4 v[188:191], v31, s[40:43], s58 offen sc1
    s_add_u32 s58, s58, 1024
    s_waitcnt vmcnt(28)
    v_mfma_f32_32x32x16_bf16 v[64:79], a[64:67], v[192:195], v[64:79]
    v_mfma_f32_32x32x16_bf16 v[80:95], a[64:67], v[196:199], v[80:95]
    v_mfma_f32_32x32x16_bf16 v[96:111], a[68:71], v[192:195], v[96:111]
    v_mfma_f32_32x32x16_bf16 v[112:127], a[68:71], v[196:199], v[112:127]
    buffer_load_dwordx4 v[192:195], v30, s[40:43], s58 offen sc1
    buffer_load_dwordx4 v[196:199], v31, s[40:43], s58 offen sc1
    s_add_u32 s58, s58, 1024
    s_waitcnt vmcnt(28)
    v_mfma_f32_32x32x16_bf16 v[64:79], a[72:75], v[200:203], v[64:79]
    v_mfma_f32_32x32x16_bf16 v[80:95], a[72:75], v[204:207], v[80:95]
    v_mfma_f32_32x32x16_bf16 v[96:111], a[76:79], v[200:203], v[96:111]
    v_mfma_f32_32x32x16_bf16 v[112:127], a[76:79], v[204:207], v[112:127]
    buffer_load_dwordx4 v[200:203], v30, s[40:43], s58 offen sc1
    buffer_load_dwordx4 v[204:207], v31, s[40:43], s58 offen sc1
    s_add_u32 s58, s58, 1024
    s_waitcnt vmcnt(28)
    v_mfma_f32_32x32x16_bf16 v[64:79], a[80:83], v[208:211], v[64:79]
    v_mfma_f32_32x32x16_bf16 v[80:95], a[80:83], v[212:215], v[80:95]
    v_mfma_f32_32x32x16_bf16 v[96:111], a[84:87], v[208:211], v[96:111]
    v_mfma_f32_32x32x16_bf16 v[112:127], a[84:87], v[212:215], v[112:127]
    buffer_load_dwordx4 v[208:211], v30, s[40:43], s58 offen sc1
    buffer_load_dwordx4 v[212:215], v31, s[40:43], s58 offen sc1
    s_add_u32 s58, s58, 1024
    s_add_u32 m0, s70, 40960
    s_nop 0
    buffer_load_dwordx4 v24, s[48:51], s35 offen lds
    s_add_u32 m0, s70, 41984
    s_nop 0
    buffer_load_dwordx4 v25, s[48:51], s35 offen lds
    s_add_u32 s35, s35, 16384
    s_waitcnt vmcnt(28)
    v_mfma_f32_32x32x16_bf16 v[64:79], a[88:91], v[216:219], v[64:79]
    v_mfma_f32_32x32x16_bf16 v[80:95], a[88:91], v[220:223], v[80:95]
    v_mfma_f32_32x32x16_bf16 v[96:111], a[92:95], v[216:219], v[96:111]
    v_mfma_f32_32x32x16_bf16 v[112:127], a[92:95], v[220:223], v[112:127]
    buffer_load_dwordx4 v[216:219], v30, s[40:43], s58 offen sc1
    buffer_load_dwordx4 v[220:223], v31, s[40:43], s58 offen sc1
    s_add_u32 s58, s58, 1024
    s_add_u32 m0, s70, 49152
    s_nop 0
    buffer_load_dwordx4 v24, s[48:51], s35 offen lds
    s_add_u32 m0, s70, 50176
    s_nop 0
    buffer_load_dwordx4 v25, s[48:51], s35 offen lds
    s_add_u32 s35, s35, 16384
    s_waitcnt vmcnt(30)
    v_mfma_f32_32x32x16_bf16 v[64:79], a[96:99], v[224:227], v[64:79]
    v_mfma_f32_32x32x16_bf16 v[80:95], a[96:99], v[228:231], v[80:95]
    v_mfma_f32_32x32x16_bf16 v[96:111], a[100:103], v[224:227], v[96:111]
    v_mfma_f32_32x32x16_bf16 v[112:127], a[100:103], v[228:231], v[112:127]
    buffer_load_dwordx4 v[224:227], v30, s[40:43], s58 offen sc1
    buffer_load_dwordx4 v[228:231], v31, s[40:43], s58 offen sc1
    s_add_u32 s58, s58, 1024
    s_add_u32 m0, s70, 57344
    s_nop 0
    buffer_load_dwordx4 v24, s[48:51], s35 offen lds
    s_add_u32 m0, s70, 58368
    s_nop 0
    buffer_load_dwordx4 v25, s[48:51], s35 offen lds
    s_add_u32 s35, s35, 16384
    s_waitcnt vmcnt(32)
    ds_read_b64_tr_b16 v[32:33], v50 offset:24576
    ds_read_b64_tr_b16 v[34:35], v50 offset:25600
    ds_read_b64_tr_b16 v[36:37], v51 offset:24576
    ds_read_b64_tr_b16 v[38:39], v51 offset:25600
    v_mfma_f32_32x32x16_bf16 v[64:79], a[104:107], v[232:235], v[64:79]
    v_mfma_f32_32x32x16_bf16 v[80:95], a[104:107], v[236:239], v[80:95]
    v_mfma_f32_32x32x16_bf16 v[96:111], a[108:111], v[232:235], v[96:111]
    v_mfma_f32_32x32x16_bf16 v[112:127], a[108:111], v[236:239], v[112:127]
    buffer_load_dwordx4 v[232:235], v30, s[40:43], s58 offen sc1
    buffer_load_dwordx4 v[236:239], v31, s[40:43], s58 offen sc1
    s_add_u32 s58, s58, 1024
    s_add_u32 m0, s70, 65536
    s_nop 0
    buffer_load_dwordx4 v24, s[48:51], s35 offen lds
    s_add_u32 m0, s70, 66560
    s_nop 0
    buffer_load_dwordx4 v25, s[48:51], s35 offen lds
    s_add_u32 s35, s35, 16384
    s_waitcnt vmcnt(34)
    ds_read_b64_tr_b16 v[40:41], v50 offset:32768
    ds_read_b64_tr_b16 v[42:43], v50 offset:33792
    ds_read_b64_tr_b16 v[44:45], v51 offset:32768
    ds_read_b64_tr_b16 v[46:47], v51 offset:33792
    s_waitcnt lgkmcnt(4)
    v_mfma_f32_32x32x16_bf16 v[64:79], v[32:35], v[128:131], v[64:79]
    v_mfma_f32_32x32x16_bf16 v[80:95], v[32:35], v[132:135], v[80:95]
    v_mfma_f32_32x32x16_bf16 v[96:111], v[36:39], v[128:131], v[96:111]
    v_mfma_f32_32x32x16_bf16 v[112:127], v[36:39], v[132:135], v[112:127]
    s_add_u32 m0, s70, 73728
    s_nop 0
    buffer_load_dwordx4 v24, s[48:51], s35 offen lds
    s_add_u32 m0, s70, 74752
    s_nop 0
    buffer_load_dwordx4 v25, s[48:51], s35 offen lds
    s_add_u32 s35, s35, 16384
    s_waitcnt vmcnt(34)
    ds_read_b64_tr_b16 v[32:33], v50 offset:40960
    ds_read_b64_tr_b16 v[34:35], v50 offset:41984
    ds_read_b64_tr_b16 v[36:37], v51 offset:40960
    ds_read_b64_tr_b16 v[38:39], v51 offset:41984
    s_waitcnt lgkmcnt(4)
    v_mfma_f32_32x32x16_bf16 v[64:79], v[40:43], v[136:139], v[64:79]
    v_mfma_f32_32x32x16_bf16 v[80:95], v[40:43], v[140:143], v[80:95]
    v_mfma_f32_32x32x16_bf16 v[96:111], v[44:47], v[136:139], v[96:111]
    v_mfma_f32_32x32x16_bf16 v[112:127], v[44:47], v[140:143], v[112:127]
    s_add_u32 m0, s70, 81920
    s_nop 0
    buffer_load_dwordx4 v24, s[48:51], s35 offen lds
    s_add_u32 m0, s70, 82944
    s_nop 0
    buffer_load_dwordx4 v25, s[48:51], s35 offen lds
    s_add_u32 s35, s35, 16384
    s_waitcnt vmcnt(34)
    ds_read_b64_tr_b16 v[40:41], v48 offset:0
    ds_read_b64_tr_b16 v[42:43], v48 offset:1024
    ds_read_b64_tr_b16 v[44:45], v49 offset:0
    ds_read_b64_tr_b16 v[46:47], v49 offset:1024
    s_waitcnt lgkmcnt(4)
    v_mfma_f32_32x32x16_bf16 v[64:79], v[32:35], v[144:147], v[64:79]
    v_mfma_f32_32x32x16_bf16 v[80:95], v[32:35], v[148:151], v[80:95]
    v_mfma_f32_32x32x16_bf16 v[96:111], v[36:39], v[144:147], v[96:111]
    v_mfma_f32_32x32x16_bf16 v[112:127], v[36:39], v[148:151], v[112:127]
    s_add_u32 s60, s65, 768
    s_lshl_b32 s60, s60, 7
    v_and_b32 v52, 31, v1
    v_lshlrev_b32 v52, 10, v52
    v_add_u32 v52, s60, v52
    buffer_load_dword v53, v52, s[76:79], 0 offen sc1
    s_waitcnt vmcnt(33)
    ds_read_b64_tr_b16 v[32:33], v48 offset:8192
    ds_read_b64_tr_b16 v[34:35], v48 offset:9216
    ds_read_b64_tr_b16 v[36:37], v49 offset:8192
    ds_read_b64_tr_b16 v[38:39], v49 offset:9216
    s_waitcnt lgkmcnt(4)
    v_mfma_f32_32x32x16_bf16 v[64:79], v[40:43], v[152:155], v[64:79]
    v_mfma_f32_32x32x16_bf16 v[80:95], v[40:43], v[156:159], v[80:95]
    v_mfma_f32_32x32x16_bf16 v[96:111], v[44:47], v[152:155], v[96:111]
    v_mfma_f32_32x32x16_bf16 v[112:127], v[44:47], v[156:159], v[112:127]
    s_waitcnt vmcnt(31)
    ds_read_b64_tr_b16 v[40:41], v48 offset:16384
    ds_read_b64_tr_b16 v[42:43], v48 offset:17408
    ds_read_b64_tr_b16 v[44:45], v49 offset:16384
    ds_read_b64_tr_b16 v[46:47], v49 offset:17408
    s_waitcnt lgkmcnt(4)
    v_mfma_f32_32x32x16_bf16 v[64:79], v[32:35], v[160:163], v[64:79]
    v_mfma_f32_32x32x16_bf16 v[80:95], v[32:35], v[164:167], v[80:95]
    v_mfma_f32_32x32x16_bf16 v[96:111], v[36:39], v[160:163], v[96:111]
    v_mfma_f32_32x32x16_bf16 v[112:127], v[36:39], v[164:167], v[112:127]
    s_waitcnt vmcnt(29)
    ds_read_b64_tr_b16 v[32:33], v48 offset:24576
    ds_read_b64_tr_b16 v[34:35], v48 offset:25600
    ds_read_b64_tr_b16 v[36:37], v49 offset:24576
    ds_read_b64_tr_b16 v[38:39], v49 offset:25600
    s_waitcnt lgkmcnt(4)
    v_mfma_f32_32x32x16_bf16 v[64:79], v[40:43], v[168:171], v[64:79]
    v_mfma_f32_32x32x16_bf16 v[80:95], v[40:43], v[172:175], v[80:95]
    v_mfma_f32_32x32x16_bf16 v[96:111], v[44:47], v[168:171], v[96:111]
    v_mfma_f32_32x32x16_bf16 v[112:127], v[44:47], v[172:175], v[112:127]
    s_waitcnt vmcnt(27)
    ds_read_b64_tr_b16 v[40:41], v48 offset:32768
    ds_read_b64_tr_b16 v[42:43], v48 offset:33792
    ds_read_b64_tr_b16 v[44:45], v49 offset:32768
    ds_read_b64_tr_b16 v[46:47], v49 offset:33792
    s_waitcnt lgkmcnt(4)
    v_mfma_f32_32x32x16_bf16 v[64:79], v[32:35], v[176:179], v[64:79]
    v_mfma_f32_32x32x16_bf16 v[80:95], v[32:35], v[180:183], v[80:95]
    v_mfma_f32_32x32x16_bf16 v[96:111], v[36:39], v[176:179], v[96:111]
    v_mfma_f32_32x32x16_bf16 v[112:127], v[36:39], v[180:183], v[112:127]
    s_waitcnt vmcnt(17)
    ds_read_b64_tr_b16 v[32:33], v48 offset:40960
    ds_read_b64_tr_b16 v[34:35], v48 offset:41984
    ds_read_b64_tr_b16 v[36:37], v49 offset:40960
    ds_read_b64_tr_b16 v[38:39], v49 offset:41984
    s_waitcnt lgkmcnt(4)
    v_mfma_f32_32x32x16_bf16 v[64:79], v[40:43], v[184:187], v[64:79]
    v_mfma_f32_32x32x16_bf16 v[80:95], v[40:43], v[188:191], v[80:95]
    v_mfma_f32_32x32x16_bf16 v[96:111], v[44:47], v[184:187], v[96:111]
    v_mfma_f32_32x32x16_bf16 v[112:127], v[44:47], v[188:191], v[112:127]
    s_waitcnt vmcnt(13)
    ds_read_b64_tr_b16 v[40:41], v48 offset:49152
    ds_read_b64_tr_b16 v[42:43], v48 offset:50176
    ds_read_b64_tr_b16 v[44:45], v49 offset:49152
    ds_read_b64_tr_b16 v[46:47], v49 offset:50176
    s_waitcnt lgkmcnt(4)
    v_mfma_f32_32x32x16_bf16 v[64:79], v[32:35], v[192:195], v[64:79]
    v_mfma_f32_32x32x16_bf16 v[80:95], v[32:35], v[196:199], v[80:95]
    v_mfma_f32_32x32x16_bf16 v[96:111], v[36:39], v[192:195], v[96:111]
    v_mfma_f32_32x32x16_bf16 v[112:127], v[36:39], v[196:199], v[112:127]
    s_waitcnt vmcnt(9)
    ds_read_b64_tr_b16 v[32:33], v48 offset:57344
    ds_read_b64_tr_b16 v[34:35], v48 offset:58368
    ds_read_b64_tr_b16 v[36:37], v49 offset:57344
    ds_read_b64_tr_b16 v[38:39], v49 offset:58368
    s_waitcnt lgkmcnt(4)
    v_mfma_f32_32x32x16_bf16 v[64:79], v[40:43], v[200:203], v[64:79]
    v_mfma_f32_32x32x16_bf16 v[80:95], v[40:43], v[204:207], v[80:95]
    v_mfma_f32_32x32x16_bf16 v[96:111], v[44:47], v[200:203], v[96:111]
    v_mfma_f32_32x32x16_bf16 v[112:127], v[44:47], v[204:207], v[112:127]
    s_waitcnt vmcnt(0)
    v_cmp_ne_u32 vcc, s33, v53
    s_cbranch_vccz L_f4_ok_21
    s_mov_b32 s60, 0
L_f4_spin_22:
    s_sleep 4
    buffer_load_dword v53, v52, s[76:79], 0 offen sc1
    s_add_u32 s60, s60, 1
    s_waitcnt vmcnt(0)
    v_cmp_ne_u32 vcc, s33, v53
    s_cmp_gt_u32 s60, 20000
    s_cbranch_scc1 L_f4_ok_21
    s_cbranch_vccnz L_f4_spin_22
L_f4_ok_21:
    v_lshrrev_b32 v6, 2, v1
    v_and_b32 v7, 3, v1
    v_lshlrev_b32 v6, 12, v6
    v_lshl_add_u32 v6, v7, 4, v6
    s_lshl_b32 s60, s65, 18
    s_lshl_b32 s61, s66, 17
    s_add_u32 s60, s60, s61
    s_lshl_b32 s61, s64, 7
    s_add_u32 s60, s60, s61
    s_lshl_b32 s61, s67, 6
    s_add_u32 s60, s60, s61
    v_add_u32 v6, s60, v6
    v_add_u32 v7, 65536, v6
    buffer_load_dwordx4 v[56:59], v6, s[44:47], 0 offen sc1
    buffer_load_dwordx4 v[60:63], v7, s[44:47], 0 offen sc1
    v_lshlrev_b32 v55, 4, v1
    v_add_u32 v54, 42496, v55
    s_add_u32 s60, s57, 32768
    v_add_u32 v6, s60, v55
    v_and_b32 v7, 15, v1
    v_lshrrev_b32 v53, 2, v7
    v_lshl_add_u32 v53, v3, 2, v53
    v_lshlrev_b32 v53, 6, v53
    v_bfe_u32 v52, v1, 4, 1
    v_lshl_add_u32 v53, v52, 5, v53
    v_and_b32 v52, 3, v1
    v_lshl_add_u32 v53, v52, 3, v53
    v_add_u32 v53, s60, v53
    s_waitcnt vmcnt(3)
    ds_read_b64_tr_b16 v[128:129], v50 offset:0
    ds_read_b64_tr_b16 v[130:131], v50 offset:1024
    ds_read_b64_tr_b16 v[132:133], v51 offset:0
    ds_read_b64_tr_b16 v[134:135], v51 offset:1024
    ds_read_b64_tr_b16 v[136:137], v50 offset:8192
    ds_read_b64_tr_b16 v[138:139], v50 offset:9216
    ds_read_b64_tr_b16 v[140:141], v51 offset:8192
    ds_read_b64_tr_b16 v[142:143], v51 offset:9216
    ds_read_b64_tr_b16 v[144:145], v50 offset:16384
    ds_read_b64_tr_b16 v[146:147], v50 offset:17408
    ds_read_b64_tr_b16 v[148:149], v51 offset:16384
    ds_read_b64_tr_b16 v[150:151], v51 offset:17408
    s_waitcnt lgkmcnt(0)
    s_barrier
    s_cmp_eq_u32 s32, 0
    s_cbranch_scc0 L_xw_24
    v_mfma_f32_32x32x16_bf16 v[80:95], v[32:35], v[212:215], v[80:95]
    v_mfma_f32_32x32x16_bf16 v[80:95], v[128:131], v[220:223], v[80:95]
    v_mfma_f32_32x32x16_bf16 v[80:95], v[136:139], v[228:231], v[80:95]
    v_mfma_f32_32x32x16_bf16 v[80:95], v[144:147], v[236:239], v[80:95]
    v_mfma_f32_32x32x16_bf16 v[96:111], v[36:39], v[208:211], v[96:111]
    v_mfma_f32_32x32x16_bf16 v[96:111], v[132:135], v[216:219], v[96:111]
    v_mfma_f32_32x32x16_bf16 v[96:111], v[140:143], v[224:227], v[96:111]
    v_mfma_f32_32x32x16_bf16 v[96:111], v[148:151], v[232:235], v[96:111]
    v_mfma_f32_32x32x16_bf16 v[112:127], v[36:39], v[212:215], v[112:127]
    s_nop 6
    ds_write_b128 v54, v[80:83] offset:20480
    v_mfma_f32_32x32x16_bf16 v[112:127], v[132:135], v[220:223], v[112:127]
    ds_write_b128 v54, v[84:87] offset:21504
    v_mfma_f32_32x32x16_bf16 v[112:127], v[140:143], v[228:231], v[112:127]
    ds_write_b128 v54, v[88:91] offset:22528
    v_mfma_f32_32x32x16_bf16 v[112:127], v[148:151], v[236:239], v[112:127]
    ds_write_b128 v54, v[92:95] offset:23552
    v_mfma_f32_32x32x16_bf16 v[64:79], v[32:35], v[208:211], v[64:79]
    ds_write_b128 v54, v[96:99] offset:28672
    v_mfma_f32_32x32x16_bf16 v[64:79], v[128:131], v[216:219], v[64:79]
    ds_write_b128 v54, v[100:103] offset:29696
    v_mfma_f32_32x32x16_bf16 v[64:79], v[136:139], v[224:227], v[64:79]
    ds_write_b128 v54, v[104:107] offset:30720
    v_mfma_f32_32x32x16_bf16 v[64:79], v[144:147], v[232:235], v[64:79]
    ds_write_b128 v54, v[108:111] offset:31744
    s_nop 2
    ds_write_b128 v54, v[112:115] offset:36864
    ds_write_b128 v54, v[116:119] offset:37888
    ds_write_b128 v54, v[120:123] offset:38912
    ds_write_b128 v54, v[124:127] offset:39936
    s_nop 3
    v_mov_b32 v152, v64
    v_mov_b32 v153, v65
    v_mov_b32 v154, v66
    v_mov_b32 v155, v67
    v_mov_b32 v156, v68
    v_mov_b32 v157, v69
    v_mov_b32 v158, v70
    v_mov_b32 v159, v71
    v_mov_b32 v160, v72
    v_mov_b32 v161, v73
    v_mov_b32 v162, v74
    v_mov_b32 v163, v75
    v_mov_b32 v164, v76
    v_mov_b32 v165, v77
    v_mov_b32 v166, v78
    v_mov_b32 v167, v79
    s_branch L_xj_23
L_xw_24:
    s_cmp_eq_u32 s32, 1
    s_cbranch_scc0 L_xw_25
    v_mfma_f32_32x32x16_bf16 v[96:111], v[36:39], v[208:211], v[96:111]
    v_mfma_f32_32x32x16_bf16 v[96:111], v[132:135], v[216:219], v[96:111]
    v_mfma_f32_32x32x16_bf16 v[96:111], v[140:143], v[224:227], v[96:111]
    v_mfma_f32_32x32x16_bf16 v[96:111], v[148:151], v[232:235], v[96:111]
    v_mfma_f32_32x32x16_bf16 v[112:127], v[36:39], v[212:215], v[112:127]
    v_mfma_f32_32x32x16_bf16 v[112:127], v[132:135], v[220:223], v[112:127]
    v_mfma_f32_32x32x16_bf16 v[112:127], v[140:143], v[228:231], v[112:127]
    v_mfma_f32_32x32x16_bf16 v[112:127], v[148:151], v[236:239], v[112:127]
    v_mfma_f32_32x32x16_bf16 v[64:79], v[32:35], v[208:211], v[64:79]
    s_nop 6
    ds_write_b128 v54, v[96:99] offset:32768
    v_mfma_f32_32x32x16_bf16 v[64:79], v[128:131], v[216:219], v[64:79]
    ds_write_b128 v54, v[100:103] offset:33792
    v_mfma_f32_32x32x16_bf16 v[64:79], v[136:139], v[224:227], v[64:79]
    ds_write_b128 v54, v[104:107] offset:34816
    v_mfma_f32_32x32x16_bf16 v[64:79], v[144:147], v[232:235], v[64:79]
    ds_write_b128 v54, v[108:111] offset:35840
    v_mfma_f32_32x32x16_bf16 v[80:95], v[32:35], v[212:215], v[80:95]
    ds_write_b128 v54, v[112:115] offset:40960
    v_mfma_f32_32x32x16_bf16 v[80:95], v[128:131], v[220:223], v[80:95]
    ds_write_b128 v54, v[116:119] offset:41984
    v_mfma_f32_32x32x16_bf16 v[80:95], v[136:139], v[228:231], v[80:95]
    ds_write_b128 v54, v[120:123] offset:43008
    v_mfma_f32_32x32x16_bf16 v[80:95], v[144:147], v[236:239], v[80:95]
    ds_write_b128 v54, v[124:127] offset:44032
    s_nop 2
    ds_write_b128 v54, v[64:67] offset:0
    ds_write_b128 v54, v[68:71] offset:1024
    ds_write_b128 v54, v[72:75] offset:2048
    ds_write_b128 v54, v[76:79] offset:3072
    s_nop 3
    v_mov_b32 v152, v80
    v_mov_b32 v153, v81
    v_mov_b32 v154, v82
    v_mov_b32 v155, v83
    v_mov_b32 v156, v84
    v_mov_b32 v157, v85
    v_mov_b32 v158, v86
    v_mov_b32 v159, v87
    v_mov_b32 v160, v88
    v_mov_b32 v161, v89
    v_mov_b32 v162, v90
    v_mov_b32 v163, v91
    v_mov_b32 v164, v92
    v_mov_b32 v165, v93
    v_mov_b32 v166, v94
    v_mov_b32 v167, v95
    s_branch L_xj_23
L_xw_25:
    s_cmp_eq_u32 s32, 2
    s_cbranch_scc0 L_xw_26
    v_mfma_f32_32x32x16_bf16 v[112:127], v[36:39], v[212:215], v[112:127]
    v_mfma_f32_32x32x16_bf16 v[112:127], v[132:135], v[220:223], v[112:127]
    v_mfma_f32_32x32x16_bf16 v[112:127], v[140:143], v[228:231], v[112:127]
    v_mfma_f32_32x32x16_bf16 v[112:127], v[148:151], v[236:239], v[112:127]
    v_mfma_f32_32x32x16_bf16 v[64:79], v[32:35], v[208:211], v[64:79]
    v_mfma_f32_32x32x16_bf16 v[64:79], v[128:131], v[216:219], v[64:79]
    v_mfma_f32_32x32x16_bf16 v[64:79], v[136:139], v[224:227], v[64:79]
    v_mfma_f32_32x32x16_bf16 v[64:79], v[144:147], v[232:235], v[64:79]
    v_mfma_f32_32x32x16_bf16 v[80:95], v[32:35], v[212:215], v[80:95]
    s_nop 6
    ds_write_b128 v54, v[112:115] offset:45056
    v_mfma_f32_32x32x16_bf16 v[80:95], v[128:131], v[220:223], v[80:95]
    ds_write_b128 v54, v[116:119] offset:46080
    v_mfma_f32_32x32x16_bf16 v[80:95], v[136:139], v[228:231], v[80:95]
    ds_write_b128 v54, v[120:123] offset:47104
    v_mfma_f32_32x32x16_bf16 v[80:95], v[144:147], v[236:239], v[80:95]
    ds_write_b128 v54, v[124:127] offset:48128
    v_mfma_f32_32x32x16_bf16 v[96:111], v[36:39], v[208:211], v[96:111]
    ds_write_b128 v54, v[64:67] offset:4096
    v_mfma_f32_32x32x16_bf16 v[96:111], v[132:135], v[216:219], v[96:111]
    ds_write_b128 v54, v[68:71] offset:5120
    v_mfma_f32_32x32x16_bf16 v[96:111], v[140:143], v[224:227], v[96:111]
    ds_write_b128 v54, v[72:75] offset:6144
    v_mfma_f32_32x32x16_bf16 v[96:111], v[148:151], v[232:235], v[96:111]
    ds_write_b128 v54, v[76:79] offset:7168
    s_nop 2
    ds_write_b128 v54, v[80:83] offset:12288
    ds_write_b128 v54, v[84:87] offset:13312
    ds_write_b128 v54, v[88:91] offset:14336
    ds_write_b128 v54, v[92:95] offset:15360
    s_nop 3
    v_mov_b32 v152, v96
    v_mov_b32 v153, v97
    v_mov_b32 v154, v98
    v_mov_b32 v155, v99
    v_mov_b32 v156, v100
    v_mov_b32 v157, v101
    v_mov_b32 v158, v102
    v_mov_b32 v159, v103
    v_mov_b32 v160, v104
    v_mov_b32 v161, v105
    v_mov_b32 v162, v106
    v_mov_b32 v163, v107
    v_mov_b32 v164, v108
    v_mov_b32 v165, v109
    v_mov_b32 v166, v110
    v_mov_b32 v167, v111
    s_branch L_xj_23
L_xw_26:
    v_mfma_f32_32x32x16_bf16 v[64:79], v[32:35], v[208:211], v[64:79]
    v_mfma_f32_32x32x16_bf16 v[64:79], v[128:131], v[216:219], v[64:79]
    v_mfma_f32_32x32x16_bf16 v[64:79], v[136:139], v[224:227], v[64:79]
    v_mfma_f32_32x32x16_bf16 v[64:79], v[144:147], v[232:235], v[64:79]
    v_mfma_f32_32x32x16_bf16 v[80:95], v[32:35], v[212:215], v[80:95]
    v_mfma_f32_32x32x16_bf16 v[80:95], v[128:131], v[220:223], v[80:95]
    v_mfma_f32_32x32x16_bf16 v[80:95], v[136:139], v[228:231], v[80:95]
    v_mfma_f32_32x32x16_bf16 v[80:95], v[144:147], v[236:239], v[80:95]
    v_mfma_f32_32x32x16_bf16 v[96:111], v[36:39], v[208:211], v[96:111]
    s_nop 6
    ds_write_b128 v54, v[64:67] offset:8192
    v_mfma_f32_32x32x16_bf16 v[96:111], v[132:135], v[216:219], v[96:111]
    ds_write_b128 v54, v[68:71] offset:9216
    v_mfma_f32_32x32x16_bf16 v[96:111], v[140:143], v[224:227], v[96:111]
    ds_write_b128 v54, v[72:75] offset:10240
    v_mfma_f32_32x32x16_bf16 v[96:111], v[148:151], v[232:235], v[96:111]
    ds_write_b128 v54, v[76:79] offset:11264
    v_mfma_f32_32x32x16_bf16 v[112:127], v[36:39], v[212:215], v[112:127]
    ds_write_b128 v54, v[80:83] offset:16384
    v_mfma_f32_32x32x16_bf16 v[112:127], v[132:135], v[220:223], v[112:127]
    ds_write_b128 v54, v[84:87] offset:17408
    v_mfma_f32_32x32x16_bf16 v[112:127], v[140:143], v[228:231], v[112:127]
    ds_write_b128 v54, v[88:91] offset:18432
    v_mfma_f32_32x32x16_bf16 v[112:127], v[148:151], v[236:239], v[112:127]
    ds_write_b128 v54, v[92:95] offset:19456
    s_nop 2
    ds_write_b128 v54, v[96:99] offset:24576
    ds_write_b128 v54, v[100:103] offset:25600
    ds_write_b128 v54, v[104:107] offset:26624
    ds_write_b128 v54, v[108:111] offset:27648
    s_nop 3
    v_mov_b32 v152, v112
    v_mov_b32 v153, v113
    v_mov_b32 v154, v114
    v_mov_b32 v155, v115
    v_mov_b32 v156, v116
    v_mov_b32 v157, v117
    v_mov_b32 v158, v118
    v_mov_b32 v159, v119
    v_mov_b32 v160, v120
    v_mov_b32 v161, v121
    v_mov_b32 v162, v122
    v_mov_b32 v163, v123
    v_mov_b32 v164, v124
    v_mov_b32 v165, v125
    v_mov_b32 v166, v126
    v_mov_b32 v167, v127
L_xj_23:
    s_waitcnt vmcnt(0)
    ds_write_b128 v6, v[56:59]
    ds_write_b128 v6, v[60:63] offset:1024
    s_waitcnt lgkmcnt(0)
    s_barrier
    ds_read_b64_tr_b16 v[56:57], v53 offset:0
    ds_read_b64_tr_b16 v[58:59], v53 offset:512
    ds_read_b64_tr_b16 v[60:61], v53 offset:1024
    ds_read_b64_tr_b16 v[62:63], v53 offset:1536
    s_mul_i32 s60, s32, 12288
    v_add_u32 v54, s60, v54
    ds_read_b128 v[168:171], v54 offset:0
    ds_read_b128 v[172:175], v54 offset:1024
    ds_read_b128 v[176:179], v54 offset:2048
    ds_read_b128 v[180:183], v54 offset:3072
    ds_read_b128 v[184:187], v54 offset:4096
    ds_read_b128 v[188:191], v54 offset:5120
    ds_read_b128 v[192:195], v54 offset:6144
    ds_read_b128 v[196:199], v54 offset:7168
    ds_read_b128 v[200:203], v54 offset:8192
    ds_read_b128 v[204:207], v54 offset:9216
    ds_read_b128 v[208:211], v54 offset:10240
    ds_read_b128 v[212:215], v54 offset:11264
    s_waitcnt lgkmcnt(12)
    v_lshlrev_b32 v4, 16, v56
    v_lshlrev_b32 v5, 16, v8
    v_fmac_f32 v240, v4, v5
    v_and_b32 v4, 0xffff0000, v56
    v_and_b32 v5, 0xffff0000, v8
    v_fmac_f32 v241, v4, v5
    v_lshlrev_b32 v4, 16, v57
    v_lshlrev_b32 v5, 16, v9
    v_fmac_f32 v242, v4, v5
    v_and_b32 v4, 0xffff0000, v57
    v_and_b32 v5, 0xffff0000, v9
    v_fmac_f32 v243, v4, v5
    v_lshlrev_b32 v4, 16, v58
    v_lshlrev_b32 v5, 16, v10
    v_fmac_f32 v244, v4, v5
    v_and_b32 v4, 0xffff0000, v58
    v_and_b32 v5, 0xffff0000, v10
    v_fmac_f32 v245, v4, v5
    v_lshlrev_b32 v4, 16, v59
    v_lshlrev_b32 v5, 16, v11
    v_fmac_f32 v246, v4, v5
    v_and_b32 v4, 0xffff0000, v59
    v_and_b32 v5, 0xffff0000, v11
    v_fmac_f32 v247, v4, v5
    v_lshlrev_b32 v4, 16, v60
    v_lshlrev_b32 v5, 16, v12
    v_fmac_f32 v248, v4, v5
    v_and_b32 v4, 0xffff0000, v60
    v_and_b32 v5, 0xffff0000, v12
    v_fmac_f32 v249, v4, v5
    v_lshlrev_b32 v4, 16, v61
    v_lshlrev_b32 v5, 16, v13
    v_fmac_f32 v250, v4, v5
    v_and_b32 v4, 0xffff0000, v61
    v_and_b32 v5, 0xffff0000, v13
    v_fmac_f32 v251, v4, v5
    v_lshlrev_b32 v4, 16, v62
    v_lshlrev_b32 v5, 16, v14
    v_fmac_f32 v252, v4, v5
    v_and_b32 v4, 0xffff0000, v62
    v_and_b32 v5, 0xffff0000, v14
    v_fmac_f32 v253, v4, v5
    v_lshlrev_b32 v4, 16, v63
    v_lshlrev_b32 v5, 16, v15
    v_fmac_f32 v254, v4, v5
    v_and_b32 v4, 0xffff0000, v63
    v_and_b32 v5, 0xffff0000, v15
    v_fmac_f32 v255, v4, v5
    s_waitcnt lgkmcnt(8)
    v_add_f32 v152, v152, v168
    v_add_f32 v153, v153, v169
    v_add_f32 v154, v154, v170
    v_add_f32 v155, v155, v171
    v_add_f32 v156, v156, v172
    v_add_f32 v157, v157, v173
    v_add_f32 v158, v158, v174
    v_add_f32 v159, v159, v175
    v_add_f32 v160, v160, v176
    v_add_f32 v161, v161, v177
    v_add_f32 v162, v162, v178
    v_add_f32 v163, v163, v179
    v_add_f32 v164, v164, v180
    v_add_f32 v165, v165, v181
    v_add_f32 v166, v166, v182
    v_add_f32 v167, v167, v183
    s_waitcnt lgkmcnt(4)
    v_add_f32 v152, v152, v184
    v_add_f32 v153, v153, v185
    v_add_f32 v154, v154, v186
    v_add_f32 v155, v155, v187
    v_add_f32 v156, v156, v188
    v_add_f32 v157, v157, v189
    v_add_f32 v158, v158, v190
    v_add_f32 v159, v159, v191
    v_add_f32 v160, v160, v192
    v_add_f32 v161, v161, v193
    v_add_f32 v162, v162, v194
    v_add_f32 v163, v163, v195
    v_add_f32 v164, v164, v196
    v_add_f32 v165, v165, v197
    v_add_f32 v166, v166, v198
    v_add_f32 v167, v167, v199
    s_waitcnt lgkmcnt(0)
    v_add_f32 v152, v152, v200
    v_fma_f32 v152, v152, v17, v240
    v_add_f32 v153, v153, v201
    v_fma_f32 v153, v153, v17, v241
    v_add_f32 v154, v154, v202
    v_fma_f32 v154, v154, v17, v242
    v_add_f32 v155, v155, v203
    v_fma_f32 v155, v155, v17, v243
    v_cvt_pk_bf16_f32 v32, v152, v153
    v_cvt_pk_bf16_f32 v33, v154, v155
    ds_write_b64 v20, v[32:33]
    v_add_f32 v156, v156, v204
    v_fma_f32 v156, v156, v17, v244
    v_add_f32 v157, v157, v205
    v_fma_f32 v157, v157, v17, v245
    v_add_f32 v158, v158, v206
    v_fma_f32 v158, v158, v17, v246
    v_add_f32 v159, v159, v207
    v_fma_f32 v159, v159, v17, v247
    v_cvt_pk_bf16_f32 v34, v156, v157
    v_cvt_pk_bf16_f32 v35, v158, v159
    ds_write_b64 v21, v[34:35]
    v_add_f32 v160, v160, v208
    v_fma_f32 v160, v160, v17, v248
    v_add_f32 v161, v161, v209
    v_fma_f32 v161, v161, v17, v249
    v_add_f32 v162, v162, v210
    v_fma_f32 v162, v162, v17, v250
    v_add_f32 v163, v163, v211
    v_fma_f32 v163, v163, v17, v251
    v_cvt_pk_bf16_f32 v36, v160, v161
    v_cvt_pk_bf16_f32 v37, v162, v163
    ds_write_b64 v22, v[36:37]
    v_add_f32 v164, v164, v212
    v_fma_f32 v164, v164, v17, v252
    v_add_f32 v165, v165, v213
    v_fma_f32 v165, v165, v17, v253
    v_add_f32 v166, v166, v214
    v_fma_f32 v166, v166, v17, v254
    v_add_f32 v167, v167, v215
    v_fma_f32 v167, v167, v17, v255
    v_cvt_pk_bf16_f32 v38, v164, v165
    v_cvt_pk_bf16_f32 v39, v166, v167
    ds_write_b64 v23, v[38:39]
    s_add_u32 s60, s57, 24576
    v_add_u32 v11, s60, v55
    s_mov_b32 s56, s26
    s_mov_b32 s57, s27
    s_mov_b32 s58, 2097152
    s_mov_b32 s59, 0x00020000
    s_waitcnt lgkmcnt(0)
    ds_read_b128 v[96:99], v11
    ds_read_b128 v[100:103], v11 offset:1024
    s_waitcnt lgkmcnt(1)
    buffer_store_dwordx4 v[96:99], v26, s[56:59], 0 offen sc1
    s_waitcnt lgkmcnt(0)
    buffer_store_dwordx4 v[100:103], v27, s[56:59], 0 offen sc1
L_end:
    s_endpgm
.section .rodata,"a"
.p2align 6
.amdhsa_kernel parallel_sum__ssm_conv_h3__dense_activation_squared_relu__prompt_kernel
  .amdhsa_next_free_vgpr 382
  .amdhsa_next_free_sgpr 80
  .amdhsa_accum_offset 256
  .amdhsa_group_segment_fixed_size 0
  .amdhsa_kernarg_size 112
  .amdhsa_user_sgpr_count 2
  .amdhsa_user_sgpr_kernarg_segment_ptr 1
  .amdhsa_system_sgpr_workgroup_id_x 1
  .amdhsa_float_denorm_mode_32 3
.end_amdhsa_kernel
```
